```python
import torch

def _softmax(x, axis=-1):
    return torch.softmax(x, dim=axis)
def _gelu(x):
    return torch.nn.functional.gelu(x, approximate="tanh")
def _silu(x):
    return torch.nn.functional.silu(x)
def _sigmoid(x):
    return torch.sigmoid(x)
def _layernorm(x, axis=-1, eps=1e-5):
    m = x.mean(dim=axis, keepdim=True)
    v = x.var(dim=axis, keepdim=True, unbiased=False)
    return (x - m) / torch.sqrt(v + eps)
def _scatter_add(tgt, idx, src, axis=0):
    return tgt.clone().index_add_(axis, idx, src)
def _segment_sum(src, seg, n):
    out = torch.zeros((n,) + src.shape[1:], dtype=src.dtype)
    return out.index_add_(0, seg, src)
def _pad(x, pw):
    flat = tuple(v for pair in reversed(pw) for v in pair)
    return torch.nn.functional.pad(x, flat)

kernel_name = 'concat_heads__mha_block_cached__gqa_block_cached__near_ridge'

def setup_inputs():

    _w = (lambda a: (lambda t: t.to(torch.bfloat16) if t.is_floating_point() else t)(torch.as_tensor(a)))
    def _A_setup():
        B, Sq, D = 8, 112, 1024
        H, Sk, Dh = 32, 512, 128
        return {
            "x": _w((lambda *s: torch.randn(*s, dtype=torch.bfloat16) * 0.8)(B, Sq, D)),
            "k_cache": _w((lambda *s: torch.randn(*s, dtype=torch.bfloat16) * 0.8)(B, H, Sk, Dh)),
            "v_cache": _w((lambda *s: torch.randn(*s, dtype=torch.bfloat16) * 0.05)(B, H, Sk, Dh)),
            "wq": _w((lambda *s: torch.randn(*s, dtype=torch.bfloat16) * 0.8)(D, H * Dh) * (D ** -0.5)),
            "wo": _w((lambda *s: torch.randn(*s, dtype=torch.bfloat16) * 0.05)(H * Dh, D) * ((H * Dh) ** -0.5)),
        }
    _A_in = _A_setup()

    def _B_setup():
        B, Sq, D = 8, 112, 1024
        Hq, Hkv, Sk, Dh = 32, 32, 512, 128
        assert Hq % Hkv == 0, (Hq, Hkv)
        return {
            "x": _w((lambda *s: torch.randn(*s, dtype=torch.bfloat16) * 0.8)(B, Sq, D)),
            "k_cache": _w((lambda *s: torch.randn(*s, dtype=torch.bfloat16) * 0.8)(B, Hkv, Sk, Dh)),
            "v_cache": _w((lambda *s: torch.randn(*s, dtype=torch.bfloat16) * 0.05)(B, Hkv, Sk, Dh)),
            "wq": _w((lambda *s: torch.randn(*s, dtype=torch.bfloat16) * 0.8)(D, Hq * Dh) * (D ** -0.5)),
            "wo": _w((lambda *s: torch.randn(*s, dtype=torch.bfloat16) * 0.05)(Hq * Dh, D) * ((Hq * Dh) ** -0.5)),
        }
    _B_in = _B_setup()

    return {
        "A_x": _A_in["x"],
        "A_k_cache": _A_in["k_cache"],
        "A_v_cache": _A_in["v_cache"],
        "A_wq": _A_in["wq"],
        "A_wo": _A_in["wo"],
        "B_x": _B_in["x"],
        "B_k_cache": _B_in["k_cache"],
        "B_v_cache": _B_in["v_cache"],
        "B_wq": _B_in["wq"],
        "B_wo": _B_in["wo"],
    }

def reference(A_x, A_k_cache, A_v_cache, A_wq, A_wo, B_x, B_k_cache, B_v_cache, B_wq, B_wo):
    def _A_ref(x, k_cache, v_cache, wq, wo):
        B, Sq, D = x.shape
        H, Dh = 32, 128
        q = (lambda x, *d: x.permute(*d))((x @ wq).reshape(B, Sq, H, Dh), 0, 2, 1, 3)
        scores = torch.einsum("bhqd,bhkd->bhqk", q, k_cache) * (Dh ** -0.5)
        p = _softmax(scores, axis=-1)
        o = torch.einsum("bhqk,bhkd->bhqd", p, v_cache)
        return (lambda x, *d: x.permute(*d))(o, 0, 2, 1, 3).reshape(B, Sq, H * Dh) @ wo

    def _B_ref(x, k_cache, v_cache, wq, wo):
        B, Sq, D = x.shape
        Hq, Dh = 32, 128
        Hkv = k_cache.shape[1]
        rep = Hq // Hkv
        q = (lambda x, *d: x.permute(*d))((x @ wq).reshape(B, Sq, Hq, Dh), 0, 2, 1, 3)
        k = (lambda x, n, axis: torch.repeat_interleave(x, n, dim=axis))(k_cache, rep, axis=1)
        v = (lambda x, n, axis: torch.repeat_interleave(x, n, dim=axis))(v_cache, rep, axis=1)
        scores = torch.einsum("bhqd,bhkd->bhqk", q, k) * (Dh ** -0.5)
        p = _softmax(scores, axis=-1)
        o = torch.einsum("bhqk,bhkd->bhqd", p, v)
        return (lambda x, *d: x.permute(*d))(o, 0, 2, 1, 3).reshape(B, Sq, Hq * Dh) @ wo

    a = _A_ref(A_x, A_k_cache, A_v_cache, A_wq, A_wo)
    b = _B_ref(B_x, B_k_cache, B_v_cache, B_wq, B_wo)
    return torch.concatenate([a, b], axis=-1)
```

```asm
; @launch grid=(256,1,1) block=(512,1,1) lds=163840
.amdgcn_target "amdgcn-amd-amdhsa--gfx950"
.text
.globl concat_heads__mha_block_cached__gqa_block_cached__near_ridge_kernel
.p2align 8
.type concat_heads__mha_block_cached__gqa_block_cached__near_ridge_kernel,@function
concat_heads__mha_block_cached__gqa_block_cached__near_ridge_kernel:
    s_cmp_ge_u32 s2, 256
    s_cbranch_scc1 L_end
    s_load_dwordx16 s[4:19], s[0:1], 0
    s_load_dwordx8 s[20:27], s[0:1], 64
    s_load_dwordx2 s[28:29], s[0:1], 96
    s_bfe_u32 s3, s2, 0x20001
    s_and_b32 s30, s2, 1
    s_lshl_b32 s30, s30, 2
    s_or_b32 s3, s3, s30
    s_andn2_b32 s2, s2, 7
    s_or_b32 s2, s2, s3
    v_lshrrev_b32 v1, 6, v0
    v_and_b32 v0, 63, v0
    v_readfirstlane_b32 s3, v1
    s_bfe_u32 s80, s2, 0x10002
    s_and_b32 s81, s2, 3
    s_bfe_u32 s82, s2, 0x20003
    s_lshr_b32 s83, s2, 5
    s_lshl_b32 s90, s81, 3
    s_lshl_b32 s35, s82, 1
    s_add_u32 s90, s90, s35
    s_and_b32 s84, s3, 3
    s_cmp_lt_u32 s3, 4
    s_cbranch_scc1 L_qmm
    v_lshrrev_b32 v4, 5, v0
    v_and_b32 v5, 31, v0
    s_and_b32 s35, s84, 1
    s_lshr_b32 s34, s84, 1
    s_lshl_b32 s86, s35, 1
    s_lshl_b32 s87, s34, 2
    s_add_u32 s88, s86, s87
    v_add_u32 v6, s88, v4
    v_lshlrev_b32 v6, 1, v6
    v_xor_b32 v5, v5, v6
    s_lshl_b32 s87, s34, 3
    s_add_u32 s86, s86, s87
    v_add_u32 v4, s86, v4
    v_lshlrev_b32 v4, 13, v4
    v_lshl_add_u32 v10, v5, 4, v4
    s_lshl_b32 s86, s86, 9
    s_add_u32 s86, s86, 28672
    v_lshrrev_b32 v4, 3, v0
    v_and_b32 v5, 7, v0
    v_lshrrev_b32 v6, 1, v4
    s_lshl_b32 s87, s35, 2
    v_add_u32 v6, s87, v6
    v_xor_b32 v5, v5, v6
    s_lshl_b32 s87, s84, 3
    v_add_u32 v4, s87, v4
    v_lshlrev_b32 v4, 11, v4
    v_lshl_add_u32 v11, v5, 4, v4
    s_lshl_b32 s87, s84, 10
    s_xor_b32 s35, s83, s82
    s_and_b32 s35, s35, 1
    s_lshl_b32 s30, s35, 22
    s_lshl_b32 s31, s35, 10
    s_mul_i32 s33, s83, 229376
    s_lshl_b32 s32, s90, 8
    s_sub_u32 s34, 0x800000, s32
    s_waitcnt lgkmcnt(0)
    s_bitcmp0_b32 s2, 2
    s_cselect_b64 s[4:5], s[4:5], s[14:15]
    s_cselect_b64 s[10:11], s[10:11], s[20:21]
    s_add_u32 s36, s4, s33
    s_addc_u32 s37, s5, 0
    s_and_b32 s37, s37, 0xffff
    s_mov_b32 s38, 229376
    s_mov_b32 s39, 0x00020000
    s_add_u32 s40, s10, s32
    s_addc_u32 s41, s11, 0
    s_and_b32 s41, s41, 0xffff
    s_mov_b32 s42, s34
    s_mov_b32 s43, 0x00020000
    s_add_u32 m0, s87, 0
    s_add_u32 s35, s31, 0
    buffer_load_dwordx4 v11, s[36:39], s35 offen lds
    s_add_u32 m0, s87, 4096
    s_add_u32 s35, s31, 65536
    buffer_load_dwordx4 v11, s[36:39], s35 offen lds
    s_add_u32 m0, s87, 8192
    s_add_u32 s35, s31, 131072
    buffer_load_dwordx4 v11, s[36:39], s35 offen lds
    s_cmp_ge_u32 s84, 2
    s_cbranch_scc1 L_xs_1
    s_add_u32 m0, s87, 12288
    s_add_u32 s35, s31, 196608
    buffer_load_dwordx4 v11, s[36:39], s35 offen lds
L_xs_1:
    s_add_u32 s31, s31, 128
    s_and_b32 s31, s31, 2047
    s_add_u32 m0, s86, 0
    s_add_u32 s35, s30, 0
    buffer_load_dwordx4 v10, s[40:43], s35 offen lds
    s_add_u32 m0, s86, 2048
    s_add_u32 s35, s30, 32768
    buffer_load_dwordx4 v10, s[40:43], s35 offen lds
    s_add_u32 m0, s86, 8192
    s_add_u32 s35, s30, 131072
    buffer_load_dwordx4 v10, s[40:43], s35 offen lds
    s_add_u32 m0, s86, 10240
    s_add_u32 s35, s30, 163840
    buffer_load_dwordx4 v10, s[40:43], s35 offen lds
    s_add_u32 s30, s30, 0x40000
    s_and_b32 s30, s30, 0x7fffff
    s_add_u32 m0, s86, 16384
    s_add_u32 s35, s30, 0
    buffer_load_dwordx4 v10, s[40:43], s35 offen lds
    s_add_u32 m0, s86, 18432
    s_add_u32 s35, s30, 32768
    buffer_load_dwordx4 v10, s[40:43], s35 offen lds
    s_add_u32 m0, s86, 24576
    s_add_u32 s35, s30, 131072
    buffer_load_dwordx4 v10, s[40:43], s35 offen lds
    s_add_u32 m0, s86, 26624
    s_add_u32 s35, s30, 163840
    buffer_load_dwordx4 v10, s[40:43], s35 offen lds
    s_add_u32 s30, s30, 0x40000
    s_and_b32 s30, s30, 0x7fffff
    s_bitcmp0_b32 s2, 2
    s_cselect_b64 s[6:7], s[6:7], s[16:17]
    s_cselect_b64 s[8:9], s[8:9], s[18:19]
    s_cselect_b64 s[12:13], s[12:13], s[22:23]
    s_lshl_b32 s35, s83, 22
    s_lshl_b32 s34, s90, 17
    s_add_u32 s35, s35, s34
    s_add_u32 s44, s6, s35
    s_addc_u32 s45, s7, 0
    s_and_b32 s45, s45, 0xffff
    s_mov_b32 s46, 262144
    s_mov_b32 s47, 0x00020000
    s_add_u32 s48, s8, s35
    s_addc_u32 s49, s9, 0
    s_and_b32 s49, s49, 0xffff
    s_mov_b32 s50, 262144
    s_mov_b32 s51, 0x00020000
    s_lshl_b32 s35, s80, 3
    s_add_u32 s35, s35, s83
    s_lshl_b32 s35, s35, 2
    s_add_u32 s35, s35, s81
    s_mul_i32 s35, s35, 229376
    s_add_u32 s52, s28, s35
    s_addc_u32 s53, s29, 0
    s_and_b32 s53, s53, 0xffff
    s_mov_b32 s54, 458752
    s_mov_b32 s55, 0x00020000
    s_lshl_b32 s35, s81, 21
    s_lshl_b32 s34, s82, 9
    s_add_u32 s35, s35, s34
    s_sub_u32 s34, 0x800000, s35
    s_add_u32 s56, s12, s35
    s_addc_u32 s57, s13, 0
    s_and_b32 s57, s57, 0xffff
    s_mov_b32 s58, s34
    s_mov_b32 s59, 0x00020000
    s_mov_b32 s60, s28
    s_and_b32 s61, s29, 0xffff
    s_mov_b32 s62, 268435456
    s_mov_b32 s63, 0x00020000
    s_lshr_b32 s91, s2, 3
    s_lshr_b32 s35, s2, 7
    s_add_u32 s91, s91, s35
    s_lshl_b32 s35, s2, 1
    s_add_u32 s91, s91, s35
    s_and_b32 s91, s91, 15
    s_lshl_b32 s91, s91, 13
    v_lshrrev_b32 v4, 4, v0
    v_and_b32 v5, 15, v0
    v_lshlrev_b32 v4, 11, v4
    v_lshl_add_u32 v2, v5, 4, v4
    s_mul_i32 s96, s84, 1056
    s_lshl_b32 s32, s84, 8
    s_waitcnt vmcnt(4)
    s_barrier
    s_add_u32 m0, s87, 14336
    s_add_u32 s35, s31, 0
    buffer_load_dwordx4 v11, s[36:39], s35 offen lds
    s_add_u32 m0, s87, 18432
    s_add_u32 s35, s31, 65536
    buffer_load_dwordx4 v11, s[36:39], s35 offen lds
    s_add_u32 m0, s87, 22528
    s_add_u32 s35, s31, 131072
    buffer_load_dwordx4 v11, s[36:39], s35 offen lds
    s_cmp_ge_u32 s84, 2
    s_cbranch_scc1 L_xs_2
    s_add_u32 m0, s87, 26624
    s_add_u32 s35, s31, 196608
    buffer_load_dwordx4 v11, s[36:39], s35 offen lds
L_xs_2:
    s_add_u32 s31, s31, 128
    s_and_b32 s31, s31, 2047
    s_add_u32 m0, s86, 32768
    s_add_u32 s35, s30, 0
    buffer_load_dwordx4 v10, s[40:43], s35 offen lds
    s_add_u32 m0, s86, 34816
    s_add_u32 s35, s30, 32768
    buffer_load_dwordx4 v10, s[40:43], s35 offen lds
    s_add_u32 m0, s86, 40960
    s_add_u32 s35, s30, 131072
    buffer_load_dwordx4 v10, s[40:43], s35 offen lds
    s_add_u32 m0, s86, 43008
    s_add_u32 s35, s30, 163840
    buffer_load_dwordx4 v10, s[40:43], s35 offen lds
    s_add_u32 s30, s30, 0x40000
    s_and_b32 s30, s30, 0x7fffff
    s_waitcnt vmcnt(7)
    s_barrier
    s_add_u32 m0, s86, 49152
    s_add_u32 s35, s30, 0
    buffer_load_dwordx4 v10, s[40:43], s35 offen lds
    s_add_u32 m0, s86, 51200
    s_add_u32 s35, s30, 32768
    buffer_load_dwordx4 v10, s[40:43], s35 offen lds
    s_add_u32 m0, s86, 57344
    s_add_u32 s35, s30, 131072
    buffer_load_dwordx4 v10, s[40:43], s35 offen lds
    s_add_u32 m0, s86, 59392
    s_add_u32 s35, s30, 163840
    buffer_load_dwordx4 v10, s[40:43], s35 offen lds
    s_add_u32 s30, s30, 0x40000
    s_and_b32 s30, s30, 0x7fffff
    s_add_u32 m0, s86, 0
    s_add_u32 s35, s30, 0
    buffer_load_dwordx4 v10, s[40:43], s35 offen lds
    s_add_u32 m0, s86, 2048
    s_add_u32 s35, s30, 32768
    buffer_load_dwordx4 v10, s[40:43], s35 offen lds
    s_add_u32 m0, s86, 8192
    s_add_u32 s35, s30, 131072
    buffer_load_dwordx4 v10, s[40:43], s35 offen lds
    s_add_u32 m0, s86, 10240
    s_add_u32 s35, s30, 163840
    buffer_load_dwordx4 v10, s[40:43], s35 offen lds
    s_add_u32 s30, s30, 0x40000
    s_and_b32 s30, s30, 0x7fffff
    s_mov_b32 s85, 0
    s_branch L_qlmid
L_qlloop:
    s_waitcnt vmcnt(11)
    s_barrier
    s_add_u32 m0, s86, 0
    s_add_u32 s35, s30, 0
    buffer_load_dwordx4 v10, s[40:43], s35 offen lds
    s_add_u32 m0, s86, 2048
    s_add_u32 s35, s30, 32768
    buffer_load_dwordx4 v10, s[40:43], s35 offen lds
    s_add_u32 m0, s86, 8192
    s_add_u32 s35, s30, 131072
    buffer_load_dwordx4 v10, s[40:43], s35 offen lds
    s_add_u32 m0, s86, 10240
    s_add_u32 s35, s30, 163840
    buffer_load_dwordx4 v10, s[40:43], s35 offen lds
    s_add_u32 s30, s30, 0x40000
    s_and_b32 s30, s30, 0x7fffff
L_qlmid:
    s_waitcnt vmcnt(8)
    s_barrier
    s_add_u32 m0, s87, 0
    s_add_u32 s35, s31, 0
    buffer_load_dwordx4 v11, s[36:39], s35 offen lds
    s_add_u32 m0, s87, 4096
    s_add_u32 s35, s31, 65536
    buffer_load_dwordx4 v11, s[36:39], s35 offen lds
    s_add_u32 m0, s87, 8192
    s_add_u32 s35, s31, 131072
    buffer_load_dwordx4 v11, s[36:39], s35 offen lds
    s_cmp_ge_u32 s84, 2
    s_cbranch_scc1 L_xs_3
    s_add_u32 m0, s87, 12288
    s_add_u32 s35, s31, 196608
    buffer_load_dwordx4 v11, s[36:39], s35 offen lds
L_xs_3:
    s_add_u32 s31, s31, 128
    s_and_b32 s31, s31, 2047
    s_add_u32 m0, s86, 16384
    s_add_u32 s35, s30, 0
    buffer_load_dwordx4 v10, s[40:43], s35 offen lds
    s_add_u32 m0, s86, 18432
    s_add_u32 s35, s30, 32768
    buffer_load_dwordx4 v10, s[40:43], s35 offen lds
    s_add_u32 m0, s86, 24576
    s_add_u32 s35, s30, 131072
    buffer_load_dwordx4 v10, s[40:43], s35 offen lds
    s_add_u32 m0, s86, 26624
    s_add_u32 s35, s30, 163840
    buffer_load_dwordx4 v10, s[40:43], s35 offen lds
    s_add_u32 s30, s30, 0x40000
    s_and_b32 s30, s30, 0x7fffff
    s_waitcnt vmcnt(11)
    s_barrier
    s_add_u32 m0, s86, 32768
    s_add_u32 s35, s30, 0
    buffer_load_dwordx4 v10, s[40:43], s35 offen lds
    s_add_u32 m0, s86, 34816
    s_add_u32 s35, s30, 32768
    buffer_load_dwordx4 v10, s[40:43], s35 offen lds
    s_add_u32 m0, s86, 40960
    s_add_u32 s35, s30, 131072
    buffer_load_dwordx4 v10, s[40:43], s35 offen lds
    s_add_u32 m0, s86, 43008
    s_add_u32 s35, s30, 163840
    buffer_load_dwordx4 v10, s[40:43], s35 offen lds
    s_add_u32 s30, s30, 0x40000
    s_and_b32 s30, s30, 0x7fffff
    s_waitcnt vmcnt(8)
    s_barrier
    s_add_u32 m0, s87, 14336
    s_add_u32 s35, s31, 0
    buffer_load_dwordx4 v11, s[36:39], s35 offen lds
    s_add_u32 m0, s87, 18432
    s_add_u32 s35, s31, 65536
    buffer_load_dwordx4 v11, s[36:39], s35 offen lds
    s_add_u32 m0, s87, 22528
    s_add_u32 s35, s31, 131072
    buffer_load_dwordx4 v11, s[36:39], s35 offen lds
    s_cmp_ge_u32 s84, 2
    s_cbranch_scc1 L_xs_4
    s_add_u32 m0, s87, 26624
    s_add_u32 s35, s31, 196608
    buffer_load_dwordx4 v11, s[36:39], s35 offen lds
L_xs_4:
    s_add_u32 s31, s31, 128
    s_and_b32 s31, s31, 2047
    s_add_u32 m0, s86, 49152
    s_add_u32 s35, s30, 0
    buffer_load_dwordx4 v10, s[40:43], s35 offen lds
    s_add_u32 m0, s86, 51200
    s_add_u32 s35, s30, 32768
    buffer_load_dwordx4 v10, s[40:43], s35 offen lds
    s_add_u32 m0, s86, 57344
    s_add_u32 s35, s30, 131072
    buffer_load_dwordx4 v10, s[40:43], s35 offen lds
    s_add_u32 m0, s86, 59392
    s_add_u32 s35, s30, 163840
    buffer_load_dwordx4 v10, s[40:43], s35 offen lds
    s_add_u32 s30, s30, 0x40000
    s_and_b32 s30, s30, 0x7fffff
    s_add_u32 s85, s85, 1
    s_cmp_lt_u32 s85, 4
    s_cbranch_scc1 L_qlloop
    s_waitcnt vmcnt(11)
    s_barrier
    s_add_u32 m0, s86, 0
    s_add_u32 s35, s30, 0
    buffer_load_dwordx4 v10, s[40:43], s35 offen lds
    s_add_u32 m0, s86, 2048
    s_add_u32 s35, s30, 32768
    buffer_load_dwordx4 v10, s[40:43], s35 offen lds
    s_add_u32 m0, s86, 8192
    s_add_u32 s35, s30, 131072
    buffer_load_dwordx4 v10, s[40:43], s35 offen lds
    s_add_u32 m0, s86, 10240
    s_add_u32 s35, s30, 163840
    buffer_load_dwordx4 v10, s[40:43], s35 offen lds
    s_add_u32 s30, s30, 0x40000
    s_and_b32 s30, s30, 0x7fffff
    s_add_u32 s35, s91, 0
    s_and_b32 s35, s35, 0x1ffff
    s_add_u32 s35, s35, s32
    s_add_u32 m0, s96, 94208
    s_add_u32 s35, s35, 0
    buffer_load_dwordx4 v2, s[44:47], s35 offen nt lds
    s_waitcnt vmcnt(9)
    s_barrier
    s_add_u32 m0, s87, 0
    s_add_u32 s35, s31, 0
    buffer_load_dwordx4 v11, s[36:39], s35 offen lds
    s_add_u32 m0, s87, 4096
    s_add_u32 s35, s31, 65536
    buffer_load_dwordx4 v11, s[36:39], s35 offen lds
    s_add_u32 m0, s87, 8192
    s_add_u32 s35, s31, 131072
    buffer_load_dwordx4 v11, s[36:39], s35 offen lds
    s_cmp_ge_u32 s84, 2
    s_cbranch_scc1 L_xs_5
    s_add_u32 m0, s87, 12288
    s_add_u32 s35, s31, 196608
    buffer_load_dwordx4 v11, s[36:39], s35 offen lds
L_xs_5:
    s_add_u32 s31, s31, 128
    s_and_b32 s31, s31, 2047
    s_add_u32 m0, s86, 16384
    s_add_u32 s35, s30, 0
    buffer_load_dwordx4 v10, s[40:43], s35 offen lds
    s_add_u32 m0, s86, 18432
    s_add_u32 s35, s30, 32768
    buffer_load_dwordx4 v10, s[40:43], s35 offen lds
    s_add_u32 m0, s86, 24576
    s_add_u32 s35, s30, 131072
    buffer_load_dwordx4 v10, s[40:43], s35 offen lds
    s_add_u32 m0, s86, 26624
    s_add_u32 s35, s30, 163840
    buffer_load_dwordx4 v10, s[40:43], s35 offen lds
    s_add_u32 s30, s30, 0x40000
    s_and_b32 s30, s30, 0x7fffff
    s_add_u32 s35, s91, 0
    s_and_b32 s35, s35, 0x1ffff
    s_add_u32 s35, s35, s32
    s_add_u32 m0, s96, 98432
    s_add_u32 s35, s35, 1024
    buffer_load_dwordx4 v2, s[44:47], s35 offen nt lds
    s_waitcnt vmcnt(13)
    s_barrier
    s_add_u32 m0, s86, 32768
    s_add_u32 s35, s30, 0
    buffer_load_dwordx4 v10, s[40:43], s35 offen lds
    s_add_u32 m0, s86, 34816
    s_add_u32 s35, s30, 32768
    buffer_load_dwordx4 v10, s[40:43], s35 offen lds
    s_add_u32 m0, s86, 40960
    s_add_u32 s35, s30, 131072
    buffer_load_dwordx4 v10, s[40:43], s35 offen lds
    s_add_u32 m0, s86, 43008
    s_add_u32 s35, s30, 163840
    buffer_load_dwordx4 v10, s[40:43], s35 offen lds
    s_add_u32 s30, s30, 0x40000
    s_and_b32 s30, s30, 0x7fffff
    s_add_u32 s35, s91, 0
    s_and_b32 s35, s35, 0x1ffff
    s_add_u32 s35, s35, s32
    s_add_u32 m0, s96, 111360
    s_add_u32 s35, s35, 131072
    buffer_load_dwordx4 v2, s[44:47], s35 offen nt lds
    s_waitcnt vmcnt(10)
    s_barrier
    s_add_u32 m0, s87, 14336
    s_add_u32 s35, s31, 0
    buffer_load_dwordx4 v11, s[36:39], s35 offen lds
    s_add_u32 m0, s87, 18432
    s_add_u32 s35, s31, 65536
    buffer_load_dwordx4 v11, s[36:39], s35 offen lds
    s_add_u32 m0, s87, 22528
    s_add_u32 s35, s31, 131072
    buffer_load_dwordx4 v11, s[36:39], s35 offen lds
    s_cmp_ge_u32 s84, 2
    s_cbranch_scc1 L_xs_6
    s_add_u32 m0, s87, 26624
    s_add_u32 s35, s31, 196608
    buffer_load_dwordx4 v11, s[36:39], s35 offen lds
L_xs_6:
    s_add_u32 s31, s31, 128
    s_and_b32 s31, s31, 2047
    s_add_u32 m0, s86, 49152
    s_add_u32 s35, s30, 0
    buffer_load_dwordx4 v10, s[40:43], s35 offen lds
    s_add_u32 m0, s86, 51200
    s_add_u32 s35, s30, 32768
    buffer_load_dwordx4 v10, s[40:43], s35 offen lds
    s_add_u32 m0, s86, 57344
    s_add_u32 s35, s30, 131072
    buffer_load_dwordx4 v10, s[40:43], s35 offen lds
    s_add_u32 m0, s86, 59392
    s_add_u32 s35, s30, 163840
    buffer_load_dwordx4 v10, s[40:43], s35 offen lds
    s_add_u32 s30, s30, 0x40000
    s_and_b32 s30, s30, 0x7fffff
    s_add_u32 s35, s91, 0
    s_and_b32 s35, s35, 0x1ffff
    s_add_u32 s35, s35, s32
    s_add_u32 m0, s96, 115584
    s_add_u32 s35, s35, 132096
    buffer_load_dwordx4 v2, s[44:47], s35 offen nt lds
    s_waitcnt vmcnt(14)
    s_barrier
    s_add_u32 m0, s86, 0
    s_add_u32 s35, s30, 0
    buffer_load_dwordx4 v10, s[40:43], s35 offen lds
    s_add_u32 m0, s86, 2048
    s_add_u32 s35, s30, 32768
    buffer_load_dwordx4 v10, s[40:43], s35 offen lds
    s_add_u32 m0, s86, 8192
    s_add_u32 s35, s30, 131072
    buffer_load_dwordx4 v10, s[40:43], s35 offen lds
    s_add_u32 m0, s86, 10240
    s_add_u32 s35, s30, 163840
    buffer_load_dwordx4 v10, s[40:43], s35 offen lds
    s_add_u32 s30, s30, 0x40000
    s_and_b32 s30, s30, 0x7fffff
    s_add_u32 s35, s91, 0
    s_and_b32 s35, s35, 0x1ffff
    s_add_u32 s35, s35, s32
    s_add_u32 m0, s96, 102656
    s_add_u32 s35, s35, 0
    buffer_load_dwordx4 v2, s[48:51], s35 offen nt lds
    s_waitcnt vmcnt(10)
    s_barrier
    s_add_u32 m0, s87, 0
    s_add_u32 s35, s31, 0
    buffer_load_dwordx4 v11, s[36:39], s35 offen lds
    s_add_u32 m0, s87, 4096
    s_add_u32 s35, s31, 65536
    buffer_load_dwordx4 v11, s[36:39], s35 offen lds
    s_add_u32 m0, s87, 8192
    s_add_u32 s35, s31, 131072
    buffer_load_dwordx4 v11, s[36:39], s35 offen lds
    s_cmp_ge_u32 s84, 2
    s_cbranch_scc1 L_xs_7
    s_add_u32 m0, s87, 12288
    s_add_u32 s35, s31, 196608
    buffer_load_dwordx4 v11, s[36:39], s35 offen lds
L_xs_7:
    s_add_u32 s31, s31, 128
    s_and_b32 s31, s31, 2047
    s_add_u32 m0, s86, 16384
    s_add_u32 s35, s30, 0
    buffer_load_dwordx4 v10, s[40:43], s35 offen lds
    s_add_u32 m0, s86, 18432
    s_add_u32 s35, s30, 32768
    buffer_load_dwordx4 v10, s[40:43], s35 offen lds
    s_add_u32 m0, s86, 24576
    s_add_u32 s35, s30, 131072
    buffer_load_dwordx4 v10, s[40:43], s35 offen lds
    s_add_u32 m0, s86, 26624
    s_add_u32 s35, s30, 163840
    buffer_load_dwordx4 v10, s[40:43], s35 offen lds
    s_add_u32 s30, s30, 0x40000
    s_and_b32 s30, s30, 0x7fffff
    s_add_u32 s35, s91, 0
    s_and_b32 s35, s35, 0x1ffff
    s_add_u32 s35, s35, s32
    s_add_u32 m0, s96, 106880
    s_add_u32 s35, s35, 1024
    buffer_load_dwordx4 v2, s[48:51], s35 offen nt lds
    s_waitcnt vmcnt(14)
    s_barrier
    s_add_u32 m0, s86, 32768
    s_add_u32 s35, s30, 0
    buffer_load_dwordx4 v10, s[40:43], s35 offen lds
    s_add_u32 m0, s86, 34816
    s_add_u32 s35, s30, 32768
    buffer_load_dwordx4 v10, s[40:43], s35 offen lds
    s_add_u32 m0, s86, 40960
    s_add_u32 s35, s30, 131072
    buffer_load_dwordx4 v10, s[40:43], s35 offen lds
    s_add_u32 m0, s86, 43008
    s_add_u32 s35, s30, 163840
    buffer_load_dwordx4 v10, s[40:43], s35 offen lds
    s_add_u32 s30, s30, 0x40000
    s_and_b32 s30, s30, 0x7fffff
    s_add_u32 s35, s91, 0
    s_and_b32 s35, s35, 0x1ffff
    s_add_u32 s35, s35, s32
    s_add_u32 m0, s96, 119808
    s_add_u32 s35, s35, 131072
    buffer_load_dwordx4 v2, s[48:51], s35 offen nt lds
    s_waitcnt vmcnt(10)
    s_barrier
    s_add_u32 m0, s87, 14336
    s_add_u32 s35, s31, 0
    buffer_load_dwordx4 v11, s[36:39], s35 offen lds
    s_add_u32 m0, s87, 18432
    s_add_u32 s35, s31, 65536
    buffer_load_dwordx4 v11, s[36:39], s35 offen lds
    s_add_u32 m0, s87, 22528
    s_add_u32 s35, s31, 131072
    buffer_load_dwordx4 v11, s[36:39], s35 offen lds
    s_cmp_ge_u32 s84, 2
    s_cbranch_scc1 L_xs_8
    s_add_u32 m0, s87, 26624
    s_add_u32 s35, s31, 196608
    buffer_load_dwordx4 v11, s[36:39], s35 offen lds
L_xs_8:
    s_add_u32 s31, s31, 128
    s_and_b32 s31, s31, 2047
    s_add_u32 m0, s86, 49152
    s_add_u32 s35, s30, 0
    buffer_load_dwordx4 v10, s[40:43], s35 offen lds
    s_add_u32 m0, s86, 51200
    s_add_u32 s35, s30, 32768
    buffer_load_dwordx4 v10, s[40:43], s35 offen lds
    s_add_u32 m0, s86, 57344
    s_add_u32 s35, s30, 131072
    buffer_load_dwordx4 v10, s[40:43], s35 offen lds
    s_add_u32 m0, s86, 59392
    s_add_u32 s35, s30, 163840
    buffer_load_dwordx4 v10, s[40:43], s35 offen lds
    s_add_u32 s30, s30, 0x40000
    s_and_b32 s30, s30, 0x7fffff
    s_add_u32 s35, s91, 0
    s_and_b32 s35, s35, 0x1ffff
    s_add_u32 s35, s35, s32
    s_add_u32 m0, s96, 124032
    s_add_u32 s35, s35, 132096
    buffer_load_dwordx4 v2, s[48:51], s35 offen nt lds
    s_waitcnt vmcnt(14)
    s_barrier
    s_add_u32 m0, s86, 0
    s_add_u32 s35, s30, 0
    buffer_load_dwordx4 v10, s[40:43], s35 offen lds
    s_add_u32 m0, s86, 2048
    s_add_u32 s35, s30, 32768
    buffer_load_dwordx4 v10, s[40:43], s35 offen lds
    s_add_u32 m0, s86, 8192
    s_add_u32 s35, s30, 131072
    buffer_load_dwordx4 v10, s[40:43], s35 offen lds
    s_add_u32 m0, s86, 10240
    s_add_u32 s35, s30, 163840
    buffer_load_dwordx4 v10, s[40:43], s35 offen lds
    s_add_u32 s30, s30, 0x40000
    s_and_b32 s30, s30, 0x7fffff
    s_add_u32 s35, s91, 8192
    s_and_b32 s35, s35, 0x1ffff
    s_add_u32 s35, s35, s32
    s_add_u32 m0, s96, 128512
    s_add_u32 s35, s35, 0
    buffer_load_dwordx4 v2, s[44:47], s35 offen nt lds
    s_waitcnt vmcnt(10)
    s_barrier
    s_add_u32 m0, s87, 0
    s_add_u32 s35, s31, 0
    buffer_load_dwordx4 v11, s[36:39], s35 offen lds
    s_add_u32 m0, s87, 4096
    s_add_u32 s35, s31, 65536
    buffer_load_dwordx4 v11, s[36:39], s35 offen lds
    s_add_u32 m0, s87, 8192
    s_add_u32 s35, s31, 131072
    buffer_load_dwordx4 v11, s[36:39], s35 offen lds
    s_cmp_ge_u32 s84, 2
    s_cbranch_scc1 L_xs_9
    s_add_u32 m0, s87, 12288
    s_add_u32 s35, s31, 196608
    buffer_load_dwordx4 v11, s[36:39], s35 offen lds
L_xs_9:
    s_add_u32 s31, s31, 128
    s_and_b32 s31, s31, 2047
    s_add_u32 m0, s86, 16384
    s_add_u32 s35, s30, 0
    buffer_load_dwordx4 v10, s[40:43], s35 offen lds
    s_add_u32 m0, s86, 18432
    s_add_u32 s35, s30, 32768
    buffer_load_dwordx4 v10, s[40:43], s35 offen lds
    s_add_u32 m0, s86, 24576
    s_add_u32 s35, s30, 131072
    buffer_load_dwordx4 v10, s[40:43], s35 offen lds
    s_add_u32 m0, s86, 26624
    s_add_u32 s35, s30, 163840
    buffer_load_dwordx4 v10, s[40:43], s35 offen lds
    s_add_u32 s30, s30, 0x40000
    s_and_b32 s30, s30, 0x7fffff
    s_add_u32 s35, s91, 8192
    s_and_b32 s35, s35, 0x1ffff
    s_add_u32 s35, s35, s32
    s_add_u32 m0, s96, 132736
    s_add_u32 s35, s35, 1024
    buffer_load_dwordx4 v2, s[44:47], s35 offen nt lds
    s_waitcnt vmcnt(14)
    s_barrier
    s_add_u32 m0, s86, 32768
    s_add_u32 s35, s30, 0
    buffer_load_dwordx4 v10, s[40:43], s35 offen lds
    s_add_u32 m0, s86, 34816
    s_add_u32 s35, s30, 32768
    buffer_load_dwordx4 v10, s[40:43], s35 offen lds
    s_add_u32 m0, s86, 40960
    s_add_u32 s35, s30, 131072
    buffer_load_dwordx4 v10, s[40:43], s35 offen lds
    s_add_u32 m0, s86, 43008
    s_add_u32 s35, s30, 163840
    buffer_load_dwordx4 v10, s[40:43], s35 offen lds
    s_add_u32 s30, s30, 0x40000
    s_and_b32 s30, s30, 0x7fffff
    s_add_u32 s35, s91, 8192
    s_and_b32 s35, s35, 0x1ffff
    s_add_u32 s35, s35, s32
    s_add_u32 m0, s96, 145664
    s_add_u32 s35, s35, 131072
    buffer_load_dwordx4 v2, s[44:47], s35 offen nt lds
    s_waitcnt vmcnt(10)
    s_barrier
    s_add_u32 m0, s87, 14336
    s_add_u32 s35, s31, 0
    buffer_load_dwordx4 v11, s[36:39], s35 offen lds
    s_add_u32 m0, s87, 18432
    s_add_u32 s35, s31, 65536
    buffer_load_dwordx4 v11, s[36:39], s35 offen lds
    s_add_u32 m0, s87, 22528
    s_add_u32 s35, s31, 131072
    buffer_load_dwordx4 v11, s[36:39], s35 offen lds
    s_cmp_ge_u32 s84, 2
    s_cbranch_scc1 L_xs_10
    s_add_u32 m0, s87, 26624
    s_add_u32 s35, s31, 196608
    buffer_load_dwordx4 v11, s[36:39], s35 offen lds
L_xs_10:
    s_add_u32 s31, s31, 128
    s_and_b32 s31, s31, 2047
    s_add_u32 m0, s86, 49152
    s_add_u32 s35, s30, 0
    buffer_load_dwordx4 v10, s[40:43], s35 offen lds
    s_add_u32 m0, s86, 51200
    s_add_u32 s35, s30, 32768
    buffer_load_dwordx4 v10, s[40:43], s35 offen lds
    s_add_u32 m0, s86, 57344
    s_add_u32 s35, s30, 131072
    buffer_load_dwordx4 v10, s[40:43], s35 offen lds
    s_add_u32 m0, s86, 59392
    s_add_u32 s35, s30, 163840
    buffer_load_dwordx4 v10, s[40:43], s35 offen lds
    s_add_u32 s30, s30, 0x40000
    s_and_b32 s30, s30, 0x7fffff
    s_add_u32 s35, s91, 8192
    s_and_b32 s35, s35, 0x1ffff
    s_add_u32 s35, s35, s32
    s_add_u32 m0, s96, 149888
    s_add_u32 s35, s35, 132096
    buffer_load_dwordx4 v2, s[44:47], s35 offen nt lds
    s_waitcnt vmcnt(14)
    s_barrier
    s_add_u32 s35, s91, 8192
    s_and_b32 s35, s35, 0x1ffff
    s_add_u32 s35, s35, s32
    s_add_u32 m0, s96, 136960
    s_add_u32 s35, s35, 0
    buffer_load_dwordx4 v2, s[48:51], s35 offen nt lds
    s_waitcnt vmcnt(6)
    s_barrier
    s_add_u32 s35, s91, 8192
    s_and_b32 s35, s35, 0x1ffff
    s_add_u32 s35, s35, s32
    s_add_u32 m0, s96, 141184
    s_add_u32 s35, s35, 1024
    buffer_load_dwordx4 v2, s[48:51], s35 offen nt lds
    s_waitcnt vmcnt(3)
    s_barrier
    s_add_u32 s35, s91, 8192
    s_and_b32 s35, s35, 0x1ffff
    s_add_u32 s35, s35, s32
    s_add_u32 m0, s96, 154112
    s_add_u32 s35, s35, 131072
    buffer_load_dwordx4 v2, s[48:51], s35 offen nt lds
    s_barrier
    s_add_u32 s35, s91, 8192
    s_and_b32 s35, s35, 0x1ffff
    s_add_u32 s35, s35, s32
    s_add_u32 m0, s96, 158336
    s_add_u32 s35, s35, 132096
    buffer_load_dwordx4 v2, s[48:51], s35 offen nt lds
    s_barrier
    s_add_u32 s35, s91, 16384
    s_and_b32 s35, s35, 0x1ffff
    s_add_u32 s35, s35, s32
    s_add_u32 m0, s96, 0
    s_add_u32 s35, s35, 0
    buffer_load_dwordx4 v2, s[44:47], s35 offen nt lds
    s_add_u32 s35, s91, 16384
    s_and_b32 s35, s35, 0x1ffff
    s_add_u32 s35, s35, s32
    s_add_u32 m0, s96, 4224
    s_add_u32 s35, s35, 1024
    buffer_load_dwordx4 v2, s[44:47], s35 offen nt lds
    s_add_u32 s35, s91, 16384
    s_and_b32 s35, s35, 0x1ffff
    s_add_u32 s35, s35, s32
    s_add_u32 m0, s96, 17152
    s_add_u32 s35, s35, 131072
    buffer_load_dwordx4 v2, s[44:47], s35 offen nt lds
    s_add_u32 s35, s91, 16384
    s_and_b32 s35, s35, 0x1ffff
    s_add_u32 s35, s35, s32
    s_add_u32 m0, s96, 21376
    s_add_u32 s35, s35, 132096
    buffer_load_dwordx4 v2, s[44:47], s35 offen nt lds
    s_add_u32 s35, s91, 16384
    s_and_b32 s35, s35, 0x1ffff
    s_add_u32 s35, s35, s32
    s_add_u32 m0, s96, 8448
    s_add_u32 s35, s35, 0
    buffer_load_dwordx4 v2, s[48:51], s35 offen nt lds
    s_add_u32 s35, s91, 16384
    s_and_b32 s35, s35, 0x1ffff
    s_add_u32 s35, s35, s32
    s_add_u32 m0, s96, 12672
    s_add_u32 s35, s35, 1024
    buffer_load_dwordx4 v2, s[48:51], s35 offen nt lds
    s_add_u32 s35, s91, 16384
    s_and_b32 s35, s35, 0x1ffff
    s_add_u32 s35, s35, s32
    s_add_u32 m0, s96, 25600
    s_add_u32 s35, s35, 131072
    buffer_load_dwordx4 v2, s[48:51], s35 offen nt lds
    s_add_u32 s35, s91, 16384
    s_and_b32 s35, s35, 0x1ffff
    s_add_u32 s35, s35, s32
    s_add_u32 m0, s96, 29824
    s_add_u32 s35, s35, 132096
    buffer_load_dwordx4 v2, s[48:51], s35 offen nt lds
    s_waitcnt vmcnt(20)
    s_branch L_join
L_qmm:
    v_lshrrev_b32 v4, 4, v0
    v_bfe_u32 v5, v0, 2, 2
    v_and_b32 v6, 3, v0
    v_lshl_add_u32 v7, v4, 3, v5
    v_lshlrev_b32 v7, 9, v7
    v_lshrrev_b32 v9, 1, v6
    v_lshl_add_u32 v7, v9, 4, v7
    v_and_b32 v9, 1, v6
    v_lshl_add_u32 v7, v9, 3, v7
    s_lshr_b32 s35, s84, 1
    s_lshl_b32 s35, s35, 8
    s_add_u32 s35, s35, 28672
    v_add_u32 v7, s35, v7
    v_and_b32 v9, 1, v4
    v_lshl_or_b32 v9, v9, 2, v5
    s_and_b32 s35, s84, 1
    s_lshl_b32 s35, s35, 2
    v_xor_b32 v9, s35, v9
    v_xor_b32 v1, 0, v9
    v_lshl_add_u32 v10, v1, 5, v7
    v_xor_b32 v1, 1, v9
    v_lshl_add_u32 v11, v1, 5, v7
    v_xor_b32 v1, 2, v9
    v_lshl_add_u32 v12, v1, 5, v7
    v_xor_b32 v1, 3, v9
    v_lshl_add_u32 v13, v1, 5, v7
    v_and_b32 v5, 15, v0
    v_lshrrev_b32 v6, 1, v5
    v_xor_b32 v6, v6, v4
    v_lshlrev_b32 v7, 7, v5
    v_lshl_add_u32 v14, v6, 4, v7
    v_xor_b32 v15, 64, v14
    v_lshlrev_b32 v5, 4, v5
    v_lshrrev_b32 v6, 5, v0
    v_lshl_add_u32 v5, v6, 8, v5
    v_bfe_u32 v6, v0, 4, 1
    v_lshl_add_u32 v5, v6, 3, v5
    s_lshr_b32 s34, s84, 1
    s_mul_i32 s34, s34, 28672
    s_and_b32 s35, s84, 1
    s_lshl_b32 s35, s35, 11
    s_add_u32 s34, s34, s35
    s_add_u32 s34, s34, 36864
    v_add_u32 v8, s34, v5
    s_mov_b32 s30, 0x3e0293ee
    s_mov_b32 s31, 0x3e0293ee
    v_lshrrev_b32 v4, 4, v0
    v_and_b32 v5, 15, v0
    v_lshlrev_b32 v4, 11, v4
    v_lshl_add_u32 v2, v5, 4, v4
    s_waitcnt lgkmcnt(0)
    s_bitcmp0_b32 s2, 2
    s_cselect_b64 s[6:7], s[6:7], s[16:17]
    s_cselect_b64 s[8:9], s[8:9], s[18:19]
    s_cselect_b64 s[12:13], s[12:13], s[22:23]
    s_lshl_b32 s35, s83, 22
    s_lshl_b32 s34, s90, 17
    s_add_u32 s35, s35, s34
    s_add_u32 s44, s6, s35
    s_addc_u32 s45, s7, 0
    s_and_b32 s45, s45, 0xffff
    s_mov_b32 s46, 262144
    s_mov_b32 s47, 0x00020000
    s_add_u32 s48, s8, s35
    s_addc_u32 s49, s9, 0
    s_and_b32 s49, s49, 0xffff
    s_mov_b32 s50, 262144
    s_mov_b32 s51, 0x00020000
    s_lshl_b32 s35, s80, 3
    s_add_u32 s35, s35, s83
    s_lshl_b32 s35, s35, 2
    s_add_u32 s35, s35, s81
    s_mul_i32 s35, s35, 229376
    s_add_u32 s52, s28, s35
    s_addc_u32 s53, s29, 0
    s_and_b32 s53, s53, 0xffff
    s_mov_b32 s54, 458752
    s_mov_b32 s55, 0x00020000
    s_lshl_b32 s35, s81, 21
    s_lshl_b32 s34, s82, 9
    s_add_u32 s35, s35, s34
    s_sub_u32 s34, 0x800000, s35
    s_add_u32 s56, s12, s35
    s_addc_u32 s57, s13, 0
    s_and_b32 s57, s57, 0xffff
    s_mov_b32 s58, s34
    s_mov_b32 s59, 0x00020000
    s_mov_b32 s60, s28
    s_and_b32 s61, s29, 0xffff
    s_mov_b32 s62, 268435456
    s_mov_b32 s63, 0x00020000
    s_lshr_b32 s91, s2, 3
    s_lshr_b32 s35, s2, 7
    s_add_u32 s91, s91, s35
    s_lshl_b32 s35, s2, 1
    s_add_u32 s91, s91, s35
    s_and_b32 s91, s91, 15
    s_lshl_b32 s91, s91, 13
    s_or_b32 s35, s2, s3
    s_cbranch_scc1 L_notag
    s_mov_b32 s36, s26
    s_and_b32 s37, s27, 0xffff
    s_mov_b32 s38, 256
    s_mov_b32 s39, 0x00020000
    v_mov_b32 v4, 50331648
    v_mov_b32 v7, 0
    s_mov_b32 s34, 1664525
    s_mov_b32 s35, 1013904223
    buffer_load_dword v5, v4, s[60:63], 0 offen sc1
    s_waitcnt vmcnt(0)
    v_mul_lo_u32 v5, v5, s34
    v_add_u32 v5, s35, v5
    v_mov_b32 v6, s35
    v_cmp_eq_u32 vcc, 0, v5
    s_nop 1
    v_cndmask_b32 v5, v5, v6, vcc
    s_mov_b64 exec, 1
    buffer_store_dword v5, v7, s[36:39], 0 offen sc1
    s_mov_b64 exec, -1
L_notag:
    s_barrier
    ds_read_b64_tr_b16 v[128:129], v10 offset:0
    ds_read_b64_tr_b16 v[130:131], v10 offset:2048
    ds_read_b128 v[144:147], v14 offset:0
    ds_read_b64_tr_b16 v[132:133], v11 offset:0
    ds_read_b64_tr_b16 v[134:135], v11 offset:2048
    ds_read_b64_tr_b16 v[136:137], v12 offset:0
    ds_read_b64_tr_b16 v[138:139], v12 offset:2048
    ds_read_b64_tr_b16 v[140:141], v13 offset:0
    ds_read_b64_tr_b16 v[142:143], v13 offset:2048
    ds_read_b128 v[148:151], v14 offset:2048
    ds_read_b128 v[152:155], v14 offset:4096
    ds_read_b128 v[156:159], v14 offset:6144
    ds_read_b128 v[160:163], v14 offset:8192
    ds_read_b128 v[164:167], v14 offset:10240
    ds_read_b128 v[168:171], v14 offset:12288
    s_setprio 1
    s_waitcnt lgkmcnt(0)
    s_barrier
    v_mfma_f32_16x16x32_bf16 v[16:19], v[128:131], v[144:147], 0
    ds_read_b64_tr_b16 v[172:173], v10 offset:16384
    v_mfma_f32_16x16x32_bf16 v[44:47], v[132:135], v[144:147], 0
    ds_read_b64_tr_b16 v[174:175], v10 offset:18432
    v_mfma_f32_16x16x32_bf16 v[72:75], v[136:139], v[144:147], 0
    ds_read_b128 v[188:191], v15 offset:0
    v_mfma_f32_16x16x32_bf16 v[100:103], v[140:143], v[144:147], 0
    ds_read_b64_tr_b16 v[176:177], v11 offset:16384
    v_mfma_f32_16x16x32_bf16 v[104:107], v[140:143], v[148:151], 0
    ds_read_b64_tr_b16 v[178:179], v11 offset:18432
    v_mfma_f32_16x16x32_bf16 v[76:79], v[136:139], v[148:151], 0
    ds_read_b64_tr_b16 v[180:181], v12 offset:16384
    v_mfma_f32_16x16x32_bf16 v[48:51], v[132:135], v[148:151], 0
    ds_read_b64_tr_b16 v[182:183], v12 offset:18432
    v_mfma_f32_16x16x32_bf16 v[20:23], v[128:131], v[148:151], 0
    ds_read_b64_tr_b16 v[184:185], v13 offset:16384
    v_mfma_f32_16x16x32_bf16 v[24:27], v[128:131], v[152:155], 0
    ds_read_b64_tr_b16 v[186:187], v13 offset:18432
    v_mfma_f32_16x16x32_bf16 v[52:55], v[132:135], v[152:155], 0
    ds_read_b128 v[192:195], v15 offset:2048
    v_mfma_f32_16x16x32_bf16 v[80:83], v[136:139], v[152:155], 0
    ds_read_b128 v[196:199], v15 offset:4096
    v_mfma_f32_16x16x32_bf16 v[108:111], v[140:143], v[152:155], 0
    ds_read_b128 v[200:203], v15 offset:6144
    v_mfma_f32_16x16x32_bf16 v[112:115], v[140:143], v[156:159], 0
    ds_read_b128 v[204:207], v15 offset:8192
    v_mfma_f32_16x16x32_bf16 v[84:87], v[136:139], v[156:159], 0
    ds_read_b128 v[208:211], v15 offset:10240
    v_mfma_f32_16x16x32_bf16 v[56:59], v[132:135], v[156:159], 0
    ds_read_b128 v[212:215], v15 offset:12288
    v_mfma_f32_16x16x32_bf16 v[28:31], v[128:131], v[156:159], 0
    v_mfma_f32_16x16x32_bf16 v[32:35], v[128:131], v[160:163], 0
    v_mfma_f32_16x16x32_bf16 v[60:63], v[132:135], v[160:163], 0
    v_mfma_f32_16x16x32_bf16 v[88:91], v[136:139], v[160:163], 0
    v_mfma_f32_16x16x32_bf16 v[116:119], v[140:143], v[160:163], 0
    v_mfma_f32_16x16x32_bf16 v[120:123], v[140:143], v[164:167], 0
    v_mfma_f32_16x16x32_bf16 v[92:95], v[136:139], v[164:167], 0
    v_mfma_f32_16x16x32_bf16 v[64:67], v[132:135], v[164:167], 0
    v_mfma_f32_16x16x32_bf16 v[36:39], v[128:131], v[164:167], 0
    v_mfma_f32_16x16x32_bf16 v[40:43], v[128:131], v[168:171], 0
    v_mfma_f32_16x16x32_bf16 v[68:71], v[132:135], v[168:171], 0
    v_mfma_f32_16x16x32_bf16 v[96:99], v[136:139], v[168:171], 0
    v_mfma_f32_16x16x32_bf16 v[124:127], v[140:143], v[168:171], 0
    s_mov_b32 s85, 0
    s_branch L_q_mid
L_q:
    s_waitcnt lgkmcnt(0)
    s_barrier
    v_mfma_f32_16x16x32_bf16 v[16:19], v[128:131], v[144:147], v[16:19]
    ds_read_b64_tr_b16 v[172:173], v10 offset:16384
    v_mfma_f32_16x16x32_bf16 v[44:47], v[132:135], v[144:147], v[44:47]
    ds_read_b64_tr_b16 v[174:175], v10 offset:18432
    v_mfma_f32_16x16x32_bf16 v[72:75], v[136:139], v[144:147], v[72:75]
    ds_read_b128 v[188:191], v15 offset:0
    v_mfma_f32_16x16x32_bf16 v[100:103], v[140:143], v[144:147], v[100:103]
    ds_read_b64_tr_b16 v[176:177], v11 offset:16384
    v_mfma_f32_16x16x32_bf16 v[104:107], v[140:143], v[148:151], v[104:107]
    ds_read_b64_tr_b16 v[178:179], v11 offset:18432
    v_mfma_f32_16x16x32_bf16 v[76:79], v[136:139], v[148:151], v[76:79]
    ds_read_b64_tr_b16 v[180:181], v12 offset:16384
    v_mfma_f32_16x16x32_bf16 v[48:51], v[132:135], v[148:151], v[48:51]
    ds_read_b64_tr_b16 v[182:183], v12 offset:18432
    v_mfma_f32_16x16x32_bf16 v[20:23], v[128:131], v[148:151], v[20:23]
    ds_read_b64_tr_b16 v[184:185], v13 offset:16384
    v_mfma_f32_16x16x32_bf16 v[24:27], v[128:131], v[152:155], v[24:27]
    ds_read_b64_tr_b16 v[186:187], v13 offset:18432
    v_mfma_f32_16x16x32_bf16 v[52:55], v[132:135], v[152:155], v[52:55]
    ds_read_b128 v[192:195], v15 offset:2048
    v_mfma_f32_16x16x32_bf16 v[80:83], v[136:139], v[152:155], v[80:83]
    ds_read_b128 v[196:199], v15 offset:4096
    v_mfma_f32_16x16x32_bf16 v[108:111], v[140:143], v[152:155], v[108:111]
    ds_read_b128 v[200:203], v15 offset:6144
    v_mfma_f32_16x16x32_bf16 v[112:115], v[140:143], v[156:159], v[112:115]
    ds_read_b128 v[204:207], v15 offset:8192
    v_mfma_f32_16x16x32_bf16 v[84:87], v[136:139], v[156:159], v[84:87]
    ds_read_b128 v[208:211], v15 offset:10240
    v_mfma_f32_16x16x32_bf16 v[56:59], v[132:135], v[156:159], v[56:59]
    ds_read_b128 v[212:215], v15 offset:12288
    v_mfma_f32_16x16x32_bf16 v[28:31], v[128:131], v[156:159], v[28:31]
    v_mfma_f32_16x16x32_bf16 v[32:35], v[128:131], v[160:163], v[32:35]
    v_mfma_f32_16x16x32_bf16 v[60:63], v[132:135], v[160:163], v[60:63]
    v_mfma_f32_16x16x32_bf16 v[88:91], v[136:139], v[160:163], v[88:91]
    v_mfma_f32_16x16x32_bf16 v[116:119], v[140:143], v[160:163], v[116:119]
    v_mfma_f32_16x16x32_bf16 v[120:123], v[140:143], v[164:167], v[120:123]
    v_mfma_f32_16x16x32_bf16 v[92:95], v[136:139], v[164:167], v[92:95]
    v_mfma_f32_16x16x32_bf16 v[64:67], v[132:135], v[164:167], v[64:67]
    v_mfma_f32_16x16x32_bf16 v[36:39], v[128:131], v[164:167], v[36:39]
    v_mfma_f32_16x16x32_bf16 v[40:43], v[128:131], v[168:171], v[40:43]
    v_mfma_f32_16x16x32_bf16 v[68:71], v[132:135], v[168:171], v[68:71]
    v_mfma_f32_16x16x32_bf16 v[96:99], v[136:139], v[168:171], v[96:99]
    v_mfma_f32_16x16x32_bf16 v[124:127], v[140:143], v[168:171], v[124:127]
L_q_mid:
    s_waitcnt lgkmcnt(0)
    s_barrier
    v_mfma_f32_16x16x32_bf16 v[16:19], v[172:175], v[188:191], v[16:19]
    ds_read_b64_tr_b16 v[128:129], v10 offset:32768
    v_mfma_f32_16x16x32_bf16 v[44:47], v[176:179], v[188:191], v[44:47]
    ds_read_b64_tr_b16 v[130:131], v10 offset:34816
    v_mfma_f32_16x16x32_bf16 v[72:75], v[180:183], v[188:191], v[72:75]
    ds_read_b128 v[144:147], v14 offset:14336
    v_mfma_f32_16x16x32_bf16 v[100:103], v[184:187], v[188:191], v[100:103]
    ds_read_b64_tr_b16 v[132:133], v11 offset:32768
    v_mfma_f32_16x16x32_bf16 v[104:107], v[184:187], v[192:195], v[104:107]
    ds_read_b64_tr_b16 v[134:135], v11 offset:34816
    v_mfma_f32_16x16x32_bf16 v[76:79], v[180:183], v[192:195], v[76:79]
    ds_read_b64_tr_b16 v[136:137], v12 offset:32768
    v_mfma_f32_16x16x32_bf16 v[48:51], v[176:179], v[192:195], v[48:51]
    ds_read_b64_tr_b16 v[138:139], v12 offset:34816
    v_mfma_f32_16x16x32_bf16 v[20:23], v[172:175], v[192:195], v[20:23]
    ds_read_b64_tr_b16 v[140:141], v13 offset:32768
    v_mfma_f32_16x16x32_bf16 v[24:27], v[172:175], v[196:199], v[24:27]
    ds_read_b64_tr_b16 v[142:143], v13 offset:34816
    v_mfma_f32_16x16x32_bf16 v[52:55], v[176:179], v[196:199], v[52:55]
    ds_read_b128 v[148:151], v14 offset:16384
    v_mfma_f32_16x16x32_bf16 v[80:83], v[180:183], v[196:199], v[80:83]
    ds_read_b128 v[152:155], v14 offset:18432
    v_mfma_f32_16x16x32_bf16 v[108:111], v[184:187], v[196:199], v[108:111]
    ds_read_b128 v[156:159], v14 offset:20480
    v_mfma_f32_16x16x32_bf16 v[112:115], v[184:187], v[200:203], v[112:115]
    ds_read_b128 v[160:163], v14 offset:22528
    v_mfma_f32_16x16x32_bf16 v[84:87], v[180:183], v[200:203], v[84:87]
    ds_read_b128 v[164:167], v14 offset:24576
    v_mfma_f32_16x16x32_bf16 v[56:59], v[176:179], v[200:203], v[56:59]
    ds_read_b128 v[168:171], v14 offset:26624
    v_mfma_f32_16x16x32_bf16 v[28:31], v[172:175], v[200:203], v[28:31]
    v_mfma_f32_16x16x32_bf16 v[32:35], v[172:175], v[204:207], v[32:35]
    v_mfma_f32_16x16x32_bf16 v[60:63], v[176:179], v[204:207], v[60:63]
    v_mfma_f32_16x16x32_bf16 v[88:91], v[180:183], v[204:207], v[88:91]
    v_mfma_f32_16x16x32_bf16 v[116:119], v[184:187], v[204:207], v[116:119]
    v_mfma_f32_16x16x32_bf16 v[120:123], v[184:187], v[208:211], v[120:123]
    v_mfma_f32_16x16x32_bf16 v[92:95], v[180:183], v[208:211], v[92:95]
    v_mfma_f32_16x16x32_bf16 v[64:67], v[176:179], v[208:211], v[64:67]
    v_mfma_f32_16x16x32_bf16 v[36:39], v[172:175], v[208:211], v[36:39]
    v_mfma_f32_16x16x32_bf16 v[40:43], v[172:175], v[212:215], v[40:43]
    v_mfma_f32_16x16x32_bf16 v[68:71], v[176:179], v[212:215], v[68:71]
    v_mfma_f32_16x16x32_bf16 v[96:99], v[180:183], v[212:215], v[96:99]
    v_mfma_f32_16x16x32_bf16 v[124:127], v[184:187], v[212:215], v[124:127]
    s_waitcnt lgkmcnt(0)
    s_barrier
    v_mfma_f32_16x16x32_bf16 v[16:19], v[128:131], v[144:147], v[16:19]
    ds_read_b64_tr_b16 v[172:173], v10 offset:49152
    v_mfma_f32_16x16x32_bf16 v[44:47], v[132:135], v[144:147], v[44:47]
    ds_read_b64_tr_b16 v[174:175], v10 offset:51200
    v_mfma_f32_16x16x32_bf16 v[72:75], v[136:139], v[144:147], v[72:75]
    ds_read_b128 v[188:191], v15 offset:14336
    v_mfma_f32_16x16x32_bf16 v[100:103], v[140:143], v[144:147], v[100:103]
    ds_read_b64_tr_b16 v[176:177], v11 offset:49152
    v_mfma_f32_16x16x32_bf16 v[104:107], v[140:143], v[148:151], v[104:107]
    ds_read_b64_tr_b16 v[178:179], v11 offset:51200
    v_mfma_f32_16x16x32_bf16 v[76:79], v[136:139], v[148:151], v[76:79]
    ds_read_b64_tr_b16 v[180:181], v12 offset:49152
    v_mfma_f32_16x16x32_bf16 v[48:51], v[132:135], v[148:151], v[48:51]
    ds_read_b64_tr_b16 v[182:183], v12 offset:51200
    v_mfma_f32_16x16x32_bf16 v[20:23], v[128:131], v[148:151], v[20:23]
    ds_read_b64_tr_b16 v[184:185], v13 offset:49152
    v_mfma_f32_16x16x32_bf16 v[24:27], v[128:131], v[152:155], v[24:27]
    ds_read_b64_tr_b16 v[186:187], v13 offset:51200
    v_mfma_f32_16x16x32_bf16 v[52:55], v[132:135], v[152:155], v[52:55]
    ds_read_b128 v[192:195], v15 offset:16384
    v_mfma_f32_16x16x32_bf16 v[80:83], v[136:139], v[152:155], v[80:83]
    ds_read_b128 v[196:199], v15 offset:18432
    v_mfma_f32_16x16x32_bf16 v[108:111], v[140:143], v[152:155], v[108:111]
    ds_read_b128 v[200:203], v15 offset:20480
    v_mfma_f32_16x16x32_bf16 v[112:115], v[140:143], v[156:159], v[112:115]
    ds_read_b128 v[204:207], v15 offset:22528
    v_mfma_f32_16x16x32_bf16 v[84:87], v[136:139], v[156:159], v[84:87]
    ds_read_b128 v[208:211], v15 offset:24576
    v_mfma_f32_16x16x32_bf16 v[56:59], v[132:135], v[156:159], v[56:59]
    ds_read_b128 v[212:215], v15 offset:26624
    v_mfma_f32_16x16x32_bf16 v[28:31], v[128:131], v[156:159], v[28:31]
    v_mfma_f32_16x16x32_bf16 v[32:35], v[128:131], v[160:163], v[32:35]
    v_mfma_f32_16x16x32_bf16 v[60:63], v[132:135], v[160:163], v[60:63]
    v_mfma_f32_16x16x32_bf16 v[88:91], v[136:139], v[160:163], v[88:91]
    v_mfma_f32_16x16x32_bf16 v[116:119], v[140:143], v[160:163], v[116:119]
    v_mfma_f32_16x16x32_bf16 v[120:123], v[140:143], v[164:167], v[120:123]
    v_mfma_f32_16x16x32_bf16 v[92:95], v[136:139], v[164:167], v[92:95]
    v_mfma_f32_16x16x32_bf16 v[64:67], v[132:135], v[164:167], v[64:67]
    v_mfma_f32_16x16x32_bf16 v[36:39], v[128:131], v[164:167], v[36:39]
    v_mfma_f32_16x16x32_bf16 v[40:43], v[128:131], v[168:171], v[40:43]
    v_mfma_f32_16x16x32_bf16 v[68:71], v[132:135], v[168:171], v[68:71]
    v_mfma_f32_16x16x32_bf16 v[96:99], v[136:139], v[168:171], v[96:99]
    v_mfma_f32_16x16x32_bf16 v[124:127], v[140:143], v[168:171], v[124:127]
    s_waitcnt lgkmcnt(0)
    s_barrier
    v_mfma_f32_16x16x32_bf16 v[16:19], v[172:175], v[188:191], v[16:19]
    ds_read_b64_tr_b16 v[128:129], v10 offset:0
    v_mfma_f32_16x16x32_bf16 v[44:47], v[176:179], v[188:191], v[44:47]
    ds_read_b64_tr_b16 v[130:131], v10 offset:2048
    v_mfma_f32_16x16x32_bf16 v[72:75], v[180:183], v[188:191], v[72:75]
    ds_read_b128 v[144:147], v14 offset:0
    v_mfma_f32_16x16x32_bf16 v[100:103], v[184:187], v[188:191], v[100:103]
    ds_read_b64_tr_b16 v[132:133], v11 offset:0
    v_mfma_f32_16x16x32_bf16 v[104:107], v[184:187], v[192:195], v[104:107]
    ds_read_b64_tr_b16 v[134:135], v11 offset:2048
    v_mfma_f32_16x16x32_bf16 v[76:79], v[180:183], v[192:195], v[76:79]
    ds_read_b64_tr_b16 v[136:137], v12 offset:0
    v_mfma_f32_16x16x32_bf16 v[48:51], v[176:179], v[192:195], v[48:51]
    ds_read_b64_tr_b16 v[138:139], v12 offset:2048
    v_mfma_f32_16x16x32_bf16 v[20:23], v[172:175], v[192:195], v[20:23]
    ds_read_b64_tr_b16 v[140:141], v13 offset:0
    v_mfma_f32_16x16x32_bf16 v[24:27], v[172:175], v[196:199], v[24:27]
    ds_read_b64_tr_b16 v[142:143], v13 offset:2048
    v_mfma_f32_16x16x32_bf16 v[52:55], v[176:179], v[196:199], v[52:55]
    ds_read_b128 v[148:151], v14 offset:2048
    v_mfma_f32_16x16x32_bf16 v[80:83], v[180:183], v[196:199], v[80:83]
    ds_read_b128 v[152:155], v14 offset:4096
    v_mfma_f32_16x16x32_bf16 v[108:111], v[184:187], v[196:199], v[108:111]
    ds_read_b128 v[156:159], v14 offset:6144
    v_mfma_f32_16x16x32_bf16 v[112:115], v[184:187], v[200:203], v[112:115]
    ds_read_b128 v[160:163], v14 offset:8192
    v_mfma_f32_16x16x32_bf16 v[84:87], v[180:183], v[200:203], v[84:87]
    ds_read_b128 v[164:167], v14 offset:10240
    v_mfma_f32_16x16x32_bf16 v[56:59], v[176:179], v[200:203], v[56:59]
    ds_read_b128 v[168:171], v14 offset:12288
    v_mfma_f32_16x16x32_bf16 v[28:31], v[172:175], v[200:203], v[28:31]
    v_mfma_f32_16x16x32_bf16 v[32:35], v[172:175], v[204:207], v[32:35]
    v_mfma_f32_16x16x32_bf16 v[60:63], v[176:179], v[204:207], v[60:63]
    v_mfma_f32_16x16x32_bf16 v[88:91], v[180:183], v[204:207], v[88:91]
    v_mfma_f32_16x16x32_bf16 v[116:119], v[184:187], v[204:207], v[116:119]
    v_mfma_f32_16x16x32_bf16 v[120:123], v[184:187], v[208:211], v[120:123]
    v_mfma_f32_16x16x32_bf16 v[92:95], v[180:183], v[208:211], v[92:95]
    v_mfma_f32_16x16x32_bf16 v[64:67], v[176:179], v[208:211], v[64:67]
    v_mfma_f32_16x16x32_bf16 v[36:39], v[172:175], v[208:211], v[36:39]
    v_mfma_f32_16x16x32_bf16 v[40:43], v[172:175], v[212:215], v[40:43]
    v_mfma_f32_16x16x32_bf16 v[68:71], v[176:179], v[212:215], v[68:71]
    v_mfma_f32_16x16x32_bf16 v[96:99], v[180:183], v[212:215], v[96:99]
    v_mfma_f32_16x16x32_bf16 v[124:127], v[184:187], v[212:215], v[124:127]
    s_add_u32 s85, s85, 1
    s_cmp_lt_u32 s85, 8
    s_cbranch_scc1 L_q
L_q_out:
    s_setprio 0
    s_waitcnt lgkmcnt(0)
    s_barrier
    v_pk_mul_f32 v[16:17], v[16:17], s[30:31]
    v_pk_mul_f32 v[18:19], v[18:19], s[30:31]
    v_cvt_pk_bf16_f32 v16, v16, v17
    v_cvt_pk_bf16_f32 v17, v18, v19
    ds_write_b64 v8, v[16:17] offset:0
    v_pk_mul_f32 v[44:45], v[44:45], s[30:31]
    v_pk_mul_f32 v[46:47], v[46:47], s[30:31]
    v_cvt_pk_bf16_f32 v44, v44, v45
    v_cvt_pk_bf16_f32 v45, v46, v47
    ds_write_b64 v8, v[44:45] offset:512
    v_pk_mul_f32 v[72:73], v[72:73], s[30:31]
    v_pk_mul_f32 v[74:75], v[74:75], s[30:31]
    v_cvt_pk_bf16_f32 v72, v72, v73
    v_cvt_pk_bf16_f32 v73, v74, v75
    ds_write_b64 v8, v[72:73] offset:1024
    v_pk_mul_f32 v[100:101], v[100:101], s[30:31]
    v_pk_mul_f32 v[102:103], v[102:103], s[30:31]
    v_cvt_pk_bf16_f32 v100, v100, v101
    v_cvt_pk_bf16_f32 v101, v102, v103
    ds_write_b64 v8, v[100:101] offset:1536
    v_pk_mul_f32 v[20:21], v[20:21], s[30:31]
    v_pk_mul_f32 v[22:23], v[22:23], s[30:31]
    v_cvt_pk_bf16_f32 v20, v20, v21
    v_cvt_pk_bf16_f32 v21, v22, v23
    ds_write_b64 v8, v[20:21] offset:4096
    v_pk_mul_f32 v[48:49], v[48:49], s[30:31]
    v_pk_mul_f32 v[50:51], v[50:51], s[30:31]
    v_cvt_pk_bf16_f32 v48, v48, v49
    v_cvt_pk_bf16_f32 v49, v50, v51
    ds_write_b64 v8, v[48:49] offset:4608
    v_pk_mul_f32 v[76:77], v[76:77], s[30:31]
    v_pk_mul_f32 v[78:79], v[78:79], s[30:31]
    v_cvt_pk_bf16_f32 v76, v76, v77
    v_cvt_pk_bf16_f32 v77, v78, v79
    ds_write_b64 v8, v[76:77] offset:5120
    v_pk_mul_f32 v[104:105], v[104:105], s[30:31]
    v_pk_mul_f32 v[106:107], v[106:107], s[30:31]
    v_cvt_pk_bf16_f32 v104, v104, v105
    v_cvt_pk_bf16_f32 v105, v106, v107
    ds_write_b64 v8, v[104:105] offset:5632
    v_pk_mul_f32 v[24:25], v[24:25], s[30:31]
    v_pk_mul_f32 v[26:27], v[26:27], s[30:31]
    v_cvt_pk_bf16_f32 v24, v24, v25
    v_cvt_pk_bf16_f32 v25, v26, v27
    ds_write_b64 v8, v[24:25] offset:8192
    v_pk_mul_f32 v[52:53], v[52:53], s[30:31]
    v_pk_mul_f32 v[54:55], v[54:55], s[30:31]
    v_cvt_pk_bf16_f32 v52, v52, v53
    v_cvt_pk_bf16_f32 v53, v54, v55
    ds_write_b64 v8, v[52:53] offset:8704
    v_pk_mul_f32 v[80:81], v[80:81], s[30:31]
    v_pk_mul_f32 v[82:83], v[82:83], s[30:31]
    v_cvt_pk_bf16_f32 v80, v80, v81
    v_cvt_pk_bf16_f32 v81, v82, v83
    ds_write_b64 v8, v[80:81] offset:9216
    v_pk_mul_f32 v[108:109], v[108:109], s[30:31]
    v_pk_mul_f32 v[110:111], v[110:111], s[30:31]
    v_cvt_pk_bf16_f32 v108, v108, v109
    v_cvt_pk_bf16_f32 v109, v110, v111
    ds_write_b64 v8, v[108:109] offset:9728
    v_pk_mul_f32 v[28:29], v[28:29], s[30:31]
    v_pk_mul_f32 v[30:31], v[30:31], s[30:31]
    v_cvt_pk_bf16_f32 v28, v28, v29
    v_cvt_pk_bf16_f32 v29, v30, v31
    ds_write_b64 v8, v[28:29] offset:12288
    v_pk_mul_f32 v[56:57], v[56:57], s[30:31]
    v_pk_mul_f32 v[58:59], v[58:59], s[30:31]
    v_cvt_pk_bf16_f32 v56, v56, v57
    v_cvt_pk_bf16_f32 v57, v58, v59
    ds_write_b64 v8, v[56:57] offset:12800
    v_pk_mul_f32 v[84:85], v[84:85], s[30:31]
    v_pk_mul_f32 v[86:87], v[86:87], s[30:31]
    v_cvt_pk_bf16_f32 v84, v84, v85
    v_cvt_pk_bf16_f32 v85, v86, v87
    ds_write_b64 v8, v[84:85] offset:13312
    v_pk_mul_f32 v[112:113], v[112:113], s[30:31]
    v_pk_mul_f32 v[114:115], v[114:115], s[30:31]
    v_cvt_pk_bf16_f32 v112, v112, v113
    v_cvt_pk_bf16_f32 v113, v114, v115
    ds_write_b64 v8, v[112:113] offset:13824
    v_pk_mul_f32 v[32:33], v[32:33], s[30:31]
    v_pk_mul_f32 v[34:35], v[34:35], s[30:31]
    v_cvt_pk_bf16_f32 v32, v32, v33
    v_cvt_pk_bf16_f32 v33, v34, v35
    ds_write_b64 v8, v[32:33] offset:16384
    v_pk_mul_f32 v[60:61], v[60:61], s[30:31]
    v_pk_mul_f32 v[62:63], v[62:63], s[30:31]
    v_cvt_pk_bf16_f32 v60, v60, v61
    v_cvt_pk_bf16_f32 v61, v62, v63
    ds_write_b64 v8, v[60:61] offset:16896
    v_pk_mul_f32 v[88:89], v[88:89], s[30:31]
    v_pk_mul_f32 v[90:91], v[90:91], s[30:31]
    v_cvt_pk_bf16_f32 v88, v88, v89
    v_cvt_pk_bf16_f32 v89, v90, v91
    ds_write_b64 v8, v[88:89] offset:17408
    v_pk_mul_f32 v[116:117], v[116:117], s[30:31]
    v_pk_mul_f32 v[118:119], v[118:119], s[30:31]
    v_cvt_pk_bf16_f32 v116, v116, v117
    v_cvt_pk_bf16_f32 v117, v118, v119
    ds_write_b64 v8, v[116:117] offset:17920
    v_pk_mul_f32 v[36:37], v[36:37], s[30:31]
    v_pk_mul_f32 v[38:39], v[38:39], s[30:31]
    v_cvt_pk_bf16_f32 v36, v36, v37
    v_cvt_pk_bf16_f32 v37, v38, v39
    ds_write_b64 v8, v[36:37] offset:20480
    v_pk_mul_f32 v[64:65], v[64:65], s[30:31]
    v_pk_mul_f32 v[66:67], v[66:67], s[30:31]
    v_cvt_pk_bf16_f32 v64, v64, v65
    v_cvt_pk_bf16_f32 v65, v66, v67
    ds_write_b64 v8, v[64:65] offset:20992
    v_pk_mul_f32 v[92:93], v[92:93], s[30:31]
    v_pk_mul_f32 v[94:95], v[94:95], s[30:31]
    v_cvt_pk_bf16_f32 v92, v92, v93
    v_cvt_pk_bf16_f32 v93, v94, v95
    ds_write_b64 v8, v[92:93] offset:21504
    v_pk_mul_f32 v[120:121], v[120:121], s[30:31]
    v_pk_mul_f32 v[122:123], v[122:123], s[30:31]
    v_cvt_pk_bf16_f32 v120, v120, v121
    v_cvt_pk_bf16_f32 v121, v122, v123
    ds_write_b64 v8, v[120:121] offset:22016
    v_pk_mul_f32 v[40:41], v[40:41], s[30:31]
    v_pk_mul_f32 v[42:43], v[42:43], s[30:31]
    v_cvt_pk_bf16_f32 v40, v40, v41
    v_cvt_pk_bf16_f32 v41, v42, v43
    ds_write_b64 v8, v[40:41] offset:24576
    v_pk_mul_f32 v[68:69], v[68:69], s[30:31]
    v_pk_mul_f32 v[70:71], v[70:71], s[30:31]
    v_cvt_pk_bf16_f32 v68, v68, v69
    v_cvt_pk_bf16_f32 v69, v70, v71
    ds_write_b64 v8, v[68:69] offset:25088
    v_pk_mul_f32 v[96:97], v[96:97], s[30:31]
    v_pk_mul_f32 v[98:99], v[98:99], s[30:31]
    v_cvt_pk_bf16_f32 v96, v96, v97
    v_cvt_pk_bf16_f32 v97, v98, v99
    ds_write_b64 v8, v[96:97] offset:25600
    v_pk_mul_f32 v[124:125], v[124:125], s[30:31]
    v_pk_mul_f32 v[126:127], v[126:127], s[30:31]
    v_cvt_pk_bf16_f32 v124, v124, v125
    v_cvt_pk_bf16_f32 v125, v126, v127
    ds_write_b64 v8, v[124:125] offset:26112
L_join:
    s_lshr_b32 s34, s3, 2
    s_mul_i32 s35, s34, 131072
    s_add_u32 s44, s44, s35
    s_addc_u32 s45, s45, 0
    s_mov_b32 s46, 131072
    s_add_u32 s48, s48, s35
    s_addc_u32 s49, s49, 0
    s_mov_b32 s50, 131072
    s_mul_i32 s30, s34, 17152
    s_mul_i32 s86, s84, 1056
    s_add_u32 s86, s86, s30
    s_add_u32 s87, s86, 8448
    v_lshlrev_b32 v5, 4, v0
    s_mul_i32 s35, s34, 28672
    s_lshl_b32 s88, s84, 13
    s_add_u32 s88, s88, s35
    s_add_u32 s88, s88, 36864
    v_add_u32 v9, s88, v5
    s_lshl_b32 s88, s84, 11
    s_add_u32 s35, s35, s88
    v_add_u32 v14, s35, v5
    v_and_b32 v7, 7, v0
    v_mul_u32_u24 v7, 1056, v7
    v_bfe_u32 v1, v0, 3, 1
    v_lshl_add_u32 v7, v1, 8, v7
    v_lshrrev_b32 v1, 4, v0
    v_lshl_add_u32 v7, v1, 4, v7
    v_add_u32 v10, s30, v7
    v_bfe_u32 v7, v0, 2, 3
    v_mul_u32_u24 v7, 1056, v7
    v_lshrrev_b32 v1, 5, v0
    v_lshl_add_u32 v7, v1, 8, v7
    v_and_b32 v1, 3, v0
    v_lshl_add_u32 v7, v1, 3, v7
    s_add_u32 s35, s30, 8448
    v_add_u32 v12, s35, v7
    v_add_u32 v11, 94208, v10
    s_lshl_b32 s35, s84, 8
    s_add_u32 s31, s91, s35
    s_add_u32 s31, s31, 24576
    s_and_b32 s31, s31, 0x1ffff
    s_mov_b32 s96, 94208
    s_mov_b32 s97, 34304
    s_mov_b32 s100, 0x41000000
    s_and_b32 s94, s82, 1
    s_add_u32 s94, s94, 1
    s_sub_u32 s94, s94, s80
    v_lshrrev_b32 v4, 5, v0
    s_lshl_b32 s35, s84, 1
    v_add_u32 v4, s35, v4
    v_and_b32 v5, 31, v0
    v_lshlrev_b32 v6, 1, v4
    v_xor_b32 v5, v5, v6
    v_lshlrev_b32 v4, 11, v4
    v_lshl_add_u32 v15, v5, 4, v4
    v_lshrrev_b32 v4, 4, v0
    v_lshlrev_b32 v4, 5, v4
    v_bfe_u32 v5, v0, 2, 2
    v_add_u32 v4, v4, v5
    s_lshl_b32 s35, s83, 2
    v_add_u32 v4, s35, v4
    v_lshlrev_b32 v4, 11, v4
    v_and_b32 v5, 3, v0
    v_lshl_add_u32 v3, v5, 7, v4
    v_mov_b32 v4, 0
    v_lshrrev_b32 v7, 2, v0
    v_lshlrev_b32 v7, 9, v7
    v_and_b32 v6, 3, v0
    v_lshl_add_u32 v7, v6, 3, v7
    v_add_u32 v7, 94208, v7
    v_bfe_u32 v6, v0, 2, 3
    v_xor_b32 v6, s84, v6
    s_add_u32 s35, s81, 0
    s_and_b32 s34, s35, 1
    s_lshl_b32 s34, s34, 2
    s_bfe_u32 s35, s35, 0x10001
    s_lshl_b32 s35, s35, 8
    v_xor_b32 v1, s34, v6
    v_lshl_add_u32 v1, v1, 5, v7
    v_add_u32 v240, s35, v1
    s_add_u32 s35, s81, 1
    s_and_b32 s34, s35, 1
    s_lshl_b32 s34, s34, 2
    s_bfe_u32 s35, s35, 0x10001
    s_lshl_b32 s35, s35, 8
    v_xor_b32 v1, s34, v6
    v_lshl_add_u32 v1, v1, 5, v7
    v_add_u32 v241, s35, v1
    s_add_u32 s35, s81, 2
    s_and_b32 s34, s35, 1
    s_lshl_b32 s34, s34, 2
    s_bfe_u32 s35, s35, 0x10001
    s_lshl_b32 s35, s35, 8
    v_xor_b32 v1, s34, v6
    v_lshl_add_u32 v1, v1, 5, v7
    v_add_u32 v242, s35, v1
    s_add_u32 s35, s81, 3
    s_and_b32 s34, s35, 1
    s_lshl_b32 s34, s34, 2
    s_bfe_u32 s35, s35, 0x10001
    s_lshl_b32 s35, s35, 8
    v_xor_b32 v1, s34, v6
    v_lshl_add_u32 v1, v1, 5, v7
    v_add_u32 v243, s35, v1
    s_mov_b32 s40, s26
    s_and_b32 s41, s27, 0xffff
    s_mov_b32 s42, 256
    s_mov_b32 s43, 0x00020000
    s_cmp_eq_u32 s84, 3
    s_waitcnt lgkmcnt(0)
    s_cbranch_scc1 L_attn1
    s_barrier
    ds_read_b128 v[16:19], v9 offset:0
    ds_read_b128 v[20:23], v9 offset:1024
    ds_read_b128 v[24:27], v9 offset:2048
    ds_read_b128 v[28:31], v9 offset:3072
    ds_read_b128 v[32:35], v9 offset:4096
    ds_read_b128 v[36:39], v9 offset:5120
    ds_read_b128 v[40:43], v9 offset:6144
    ds_read_b128 v[44:47], v9 offset:7168
    ds_read_b128 v[160:163], v11 offset:0
    ds_read_b128 v[176:179], v11 offset:512
    ds_read_b128 v[164:167], v11 offset:64
    ds_read_b128 v[180:183], v11 offset:576
    ds_read_b128 v[168:171], v11 offset:128
    ds_read_b128 v[184:187], v11 offset:640
    ds_read_b128 v[172:175], v11 offset:192
    ds_read_b128 v[188:191], v11 offset:704
    s_waitcnt lgkmcnt(8)
    s_barrier
    s_waitcnt lgkmcnt(7)
    v_mfma_f32_16x16x32_bf16 v[112:115], v[160:163], v[16:19], 0
    s_add_u32 s34, s97, s86
    s_add_u32 m0, s34, 0
    s_add_u32 s35, s31, 0
    buffer_load_dwordx4 v2, s[44:47], s35 offen nt lds
    v_mfma_f32_16x16x32_bf16 v[120:123], v[160:163], v[32:35], 0
    s_waitcnt lgkmcnt(6)
    v_mfma_f32_16x16x32_bf16 v[124:127], v[176:179], v[32:35], 0
    s_add_u32 s34, s97, s86
    s_add_u32 m0, s34, 4224
    s_add_u32 s35, s31, 1024
    buffer_load_dwordx4 v2, s[44:47], s35 offen nt lds
    v_mfma_f32_16x16x32_bf16 v[116:119], v[176:179], v[16:19], 0
    s_waitcnt lgkmcnt(5)
    v_mfma_f32_16x16x32_bf16 v[112:115], v[164:167], v[20:23], v[112:115]
    v_mfma_f32_16x16x32_bf16 v[120:123], v[164:167], v[36:39], v[120:123]
    s_waitcnt lgkmcnt(4)
    v_mfma_f32_16x16x32_bf16 v[124:127], v[180:183], v[36:39], v[124:127]
    v_mfma_f32_16x16x32_bf16 v[116:119], v[180:183], v[20:23], v[116:119]
    s_waitcnt lgkmcnt(3)
    v_mfma_f32_16x16x32_bf16 v[112:115], v[168:171], v[24:27], v[112:115]
    v_mfma_f32_16x16x32_bf16 v[120:123], v[168:171], v[40:43], v[120:123]
    s_waitcnt lgkmcnt(2)
    v_mfma_f32_16x16x32_bf16 v[124:127], v[184:187], v[40:43], v[124:127]
    v_mfma_f32_16x16x32_bf16 v[116:119], v[184:187], v[24:27], v[116:119]
    s_waitcnt lgkmcnt(1)
    v_mfma_f32_16x16x32_bf16 v[112:115], v[172:175], v[28:31], v[112:115]
    v_mfma_f32_16x16x32_bf16 v[120:123], v[172:175], v[44:47], v[120:123]
    s_waitcnt lgkmcnt(0)
    v_mfma_f32_16x16x32_bf16 v[124:127], v[188:191], v[44:47], v[124:127]
    v_mfma_f32_16x16x32_bf16 v[116:119], v[188:191], v[28:31], v[116:119]
    s_nop 7
    v_max3_f32 v234, v112, v113, v114
    v_max3_f32 v235, v115, v116, v117
    v_max3_f32 v234, v234, v118, v119
    v_max_f32 v234, v234, v235
    s_nop 0
    v_mov_b32 v235, v234
    s_nop 1
    v_permlane16_swap_b32 v235, v234
    s_nop 1
    v_max_f32 v234, v234, v235
    s_nop 0
    v_mov_b32 v235, v234
    s_nop 1
    v_permlane32_swap_b32 v235, v234
    s_nop 1
    v_max_f32 v234, v234, v235
    v_mov_b32 v232, 0
    v_sub_f32 v112, v112, v234
    v_sub_f32 v113, v113, v234
    v_sub_f32 v114, v114, v234
    v_sub_f32 v115, v115, v234
    v_sub_f32 v116, v116, v234
    v_sub_f32 v117, v117, v234
    v_sub_f32 v118, v118, v234
    v_sub_f32 v119, v119, v234
    v_sub_f32 v144, 0, v234
    v_sub_f32 v145, 0, v234
    v_sub_f32 v146, 0, v234
    v_sub_f32 v147, 0, v234
    v_max3_f32 v234, v120, v121, v122
    v_max3_f32 v235, v123, v124, v125
    v_max3_f32 v234, v234, v126, v127
    v_max_f32 v234, v234, v235
    s_nop 0
    v_mov_b32 v235, v234
    s_nop 1
    v_permlane16_swap_b32 v235, v234
    s_nop 1
    v_max_f32 v234, v234, v235
    s_nop 0
    v_mov_b32 v235, v234
    s_nop 1
    v_permlane32_swap_b32 v235, v234
    s_nop 1
    v_max_f32 v234, v234, v235
    v_mov_b32 v233, 0
    v_sub_f32 v120, v120, v234
    v_sub_f32 v121, v121, v234
    v_sub_f32 v122, v122, v234
    v_sub_f32 v123, v123, v234
    v_sub_f32 v124, v124, v234
    v_sub_f32 v125, v125, v234
    v_sub_f32 v126, v126, v234
    v_sub_f32 v127, v127, v234
    v_sub_f32 v148, 0, v234
    v_sub_f32 v149, 0, v234
    v_sub_f32 v150, 0, v234
    v_sub_f32 v151, 0, v234
    s_waitcnt vmcnt(14)
    s_barrier
    s_add_u32 s98, s96, 34304
    s_cmp_eq_u32 s96, 128512
    s_cselect_b32 s98, 0, s98
    s_cmp_eq_u32 s96, 34304
    s_cselect_b32 s98, 94208, s98
    v_add_u32 v11, s98, v10
    v_add_u32 v13, s96, v12
    s_add_u32 s30, s31, 8192
    s_and_b32 s30, s30, 0x1ffff
    ds_read_b128 v[160:163], v11 offset:0
    ds_read_b128 v[176:179], v11 offset:512
    ds_read_b128 v[164:167], v11 offset:64
    ds_read_b128 v[180:183], v11 offset:576
    ds_read_b128 v[168:171], v11 offset:128
    ds_read_b128 v[184:187], v11 offset:640
    ds_read_b128 v[172:175], v11 offset:192
    ds_read_b128 v[188:191], v11 offset:704
    v_exp_f32 v112, v112
    v_exp_f32 v113, v113
    v_exp_f32 v114, v114
    v_exp_f32 v115, v115
    v_exp_f32 v116, v116
    v_exp_f32 v117, v117
    v_exp_f32 v118, v118
    v_exp_f32 v119, v119
    s_waitcnt lgkmcnt(7)
    v_mfma_f32_16x16x32_bf16 v[128:131], v[160:163], v[16:19], v[144:147]
    ds_read_b64_tr_b16 v[192:193], v13 offset:0
    v_exp_f32 v120, v120
    v_mfma_f32_16x16x32_bf16 v[136:139], v[160:163], v[32:35], v[148:151]
    ds_read_b64_tr_b16 v[194:195], v13 offset:512
    v_cvt_pk_bf16_f32 v224, v112, v113
    s_waitcnt lgkmcnt(8)
    v_mfma_f32_16x16x32_bf16 v[140:143], v[176:179], v[32:35], v[148:151]
    ds_read_b64_tr_b16 v[196:197], v13 offset:32
    v_exp_f32 v121, v121
    v_mfma_f32_16x16x32_bf16 v[132:135], v[176:179], v[16:19], v[144:147]
    ds_read_b64_tr_b16 v[198:199], v13 offset:544
    v_cvt_pk_bf16_f32 v225, v114, v115
    s_waitcnt lgkmcnt(9)
    v_mfma_f32_16x16x32_bf16 v[128:131], v[164:167], v[20:23], v[128:131]
    ds_read_b64_tr_b16 v[200:201], v13 offset:64
    v_exp_f32 v122, v122
    v_mfma_f32_16x16x32_bf16 v[136:139], v[164:167], v[36:39], v[136:139]
    ds_read_b64_tr_b16 v[202:203], v13 offset:576
    v_cvt_pk_bf16_f32 v226, v116, v117
    s_waitcnt lgkmcnt(10)
    v_mfma_f32_16x16x32_bf16 v[140:143], v[180:183], v[36:39], v[140:143]
    ds_read_b64_tr_b16 v[204:205], v13 offset:96
    v_exp_f32 v123, v123
    v_mfma_f32_16x16x32_bf16 v[132:135], v[180:183], v[20:23], v[132:135]
    ds_read_b64_tr_b16 v[206:207], v13 offset:608
    v_cvt_pk_bf16_f32 v227, v118, v119
    s_waitcnt lgkmcnt(11)
    v_mfma_f32_16x16x32_bf16 v[128:131], v[168:171], v[24:27], v[128:131]
    ds_read_b64_tr_b16 v[208:209], v13 offset:128
    v_exp_f32 v124, v124
    v_mfma_f32_16x16x32_bf16 v[136:139], v[168:171], v[40:43], v[136:139]
    ds_read_b64_tr_b16 v[210:211], v13 offset:640
    v_exp_f32 v125, v125
    s_waitcnt lgkmcnt(12)
    v_mfma_f32_16x16x32_bf16 v[140:143], v[184:187], v[40:43], v[140:143]
    ds_read_b64_tr_b16 v[212:213], v13 offset:160
    v_cvt_pk_bf16_f32 v228, v120, v121
    v_mfma_f32_16x16x32_bf16 v[132:135], v[184:187], v[24:27], v[132:135]
    ds_read_b64_tr_b16 v[214:215], v13 offset:672
    v_exp_f32 v126, v126
    s_waitcnt lgkmcnt(13)
    v_mfma_f32_16x16x32_bf16 v[128:131], v[172:175], v[28:31], v[128:131]
    ds_read_b64_tr_b16 v[216:217], v13 offset:192
    v_cvt_pk_bf16_f32 v229, v122, v123
    v_mfma_f32_16x16x32_bf16 v[136:139], v[172:175], v[44:47], v[136:139]
    ds_read_b64_tr_b16 v[218:219], v13 offset:704
    v_exp_f32 v127, v127
    s_waitcnt lgkmcnt(14)
    v_mfma_f32_16x16x32_bf16 v[140:143], v[188:191], v[44:47], v[140:143]
    ds_read_b64_tr_b16 v[220:221], v13 offset:224
    v_cvt_pk_bf16_f32 v230, v124, v125
    v_mfma_f32_16x16x32_bf16 v[132:135], v[188:191], v[28:31], v[132:135]
    ds_read_b64_tr_b16 v[222:223], v13 offset:736
    v_cvt_pk_bf16_f32 v231, v126, v127
    s_nop 0
    s_waitcnt lgkmcnt(14)
    v_mfma_f32_16x16x32_bf16 v[48:51], v[192:195], v[224:227], 0
    v_add_f32 v232, v232, v112
    v_add_f32 v233, v233, v120
    s_add_u32 s34, s96, s86
    s_add_u32 m0, s34, 0
    s_add_u32 s35, s30, 0
    buffer_load_dwordx4 v2, s[44:47], s35 offen nt lds
    v_mfma_f32_16x16x32_bf16 v[80:83], v[192:195], v[228:231], 0
    v_add_f32 v232, v232, v113
    s_waitcnt lgkmcnt(12)
    v_mfma_f32_16x16x32_bf16 v[84:87], v[196:199], v[228:231], 0
    v_add_f32 v233, v233, v121
    v_mfma_f32_16x16x32_bf16 v[52:55], v[196:199], v[224:227], 0
    v_add_f32 v232, v232, v114
    s_add_u32 s34, s97, s87
    s_add_u32 m0, s34, 0
    s_add_u32 s35, s31, 0
    buffer_load_dwordx4 v2, s[48:51], s35 offen nt lds
    s_waitcnt lgkmcnt(10)
    v_mfma_f32_16x16x32_bf16 v[56:59], v[200:203], v[224:227], 0
    v_add_f32 v233, v233, v122
    v_mfma_f32_16x16x32_bf16 v[88:91], v[200:203], v[228:231], 0
    v_add_f32 v232, v232, v115
    s_waitcnt lgkmcnt(8)
    v_mfma_f32_16x16x32_bf16 v[92:95], v[204:207], v[228:231], 0
    v_add_f32 v233, v233, v123
    v_mfma_f32_16x16x32_bf16 v[60:63], v[204:207], v[224:227], 0
    v_add_f32 v232, v232, v116
    s_add_u32 s34, s96, s86
    s_add_u32 m0, s34, 4224
    s_add_u32 s35, s30, 1024
    buffer_load_dwordx4 v2, s[44:47], s35 offen nt lds
    v_max3_f32 v234, v128, v129, v130
    s_waitcnt lgkmcnt(6)
    v_mfma_f32_16x16x32_bf16 v[64:67], v[208:211], v[224:227], 0
    v_add_f32 v233, v233, v124
    v_max3_f32 v235, v131, v132, v133
    v_mfma_f32_16x16x32_bf16 v[96:99], v[208:211], v[228:231], 0
    v_add_f32 v232, v232, v117
    v_max3_f32 v234, v234, v134, v135
    s_waitcnt lgkmcnt(4)
    v_mfma_f32_16x16x32_bf16 v[100:103], v[212:215], v[228:231], 0
    v_add_f32 v233, v233, v125
    v_max3_f32 v235, v235, v136, v137
    v_mfma_f32_16x16x32_bf16 v[68:71], v[212:215], v[224:227], 0
    v_add_f32 v232, v232, v118
    s_add_u32 s34, s97, s87
    s_add_u32 m0, s34, 4224
    s_add_u32 s35, s31, 1024
    buffer_load_dwordx4 v2, s[48:51], s35 offen nt lds
    v_max3_f32 v234, v234, v138, v139
    s_waitcnt lgkmcnt(2)
    v_mfma_f32_16x16x32_bf16 v[72:75], v[216:219], v[224:227], 0
    v_add_f32 v233, v233, v126
    v_max3_f32 v235, v235, v140, v141
    v_mfma_f32_16x16x32_bf16 v[104:107], v[216:219], v[228:231], 0
    v_add_f32 v232, v232, v119
    v_max3_f32 v234, v234, v142, v143
    s_waitcnt lgkmcnt(0)
    v_mfma_f32_16x16x32_bf16 v[108:111], v[220:223], v[228:231], 0
    v_add_f32 v233, v233, v127
    v_max_f32 v234, v234, v235
    v_mfma_f32_16x16x32_bf16 v[76:79], v[220:223], v[224:227], 0
    v_cmp_lt_f32 vcc, s100, v234
    s_mov_b32 s97, s96
    s_mov_b32 s96, s98
    s_mov_b32 s31, s30
    s_cbranch_vccnz L_stub_11
L_back_12:
    s_waitcnt vmcnt(10)
    s_barrier
    s_add_u32 s98, s96, 34304
    s_cmp_eq_u32 s96, 128512
    s_cselect_b32 s98, 0, s98
    s_cmp_eq_u32 s96, 34304
    s_cselect_b32 s98, 94208, s98
    v_add_u32 v11, s98, v10
    v_add_u32 v13, s96, v12
    s_add_u32 s30, s31, 8192
    s_and_b32 s30, s30, 0x1ffff
    ds_read_b128 v[160:163], v11 offset:0
    ds_read_b128 v[176:179], v11 offset:512
    ds_read_b128 v[164:167], v11 offset:64
    ds_read_b128 v[180:183], v11 offset:576
    ds_read_b128 v[168:171], v11 offset:128
    ds_read_b128 v[184:187], v11 offset:640
    ds_read_b128 v[172:175], v11 offset:192
    ds_read_b128 v[188:191], v11 offset:704
    v_exp_f32 v128, v128
    v_exp_f32 v129, v129
    v_exp_f32 v130, v130
    v_exp_f32 v131, v131
    v_exp_f32 v132, v132
    v_exp_f32 v133, v133
    v_exp_f32 v134, v134
    v_exp_f32 v135, v135
    s_waitcnt lgkmcnt(7)
    v_mfma_f32_16x16x32_bf16 v[112:115], v[160:163], v[16:19], v[144:147]
    ds_read_b64_tr_b16 v[192:193], v13 offset:0
    v_exp_f32 v136, v136
    v_mfma_f32_16x16x32_bf16 v[120:123], v[160:163], v[32:35], v[148:151]
    ds_read_b64_tr_b16 v[194:195], v13 offset:512
    v_cvt_pk_bf16_f32 v224, v128, v129
    s_waitcnt lgkmcnt(8)
    v_mfma_f32_16x16x32_bf16 v[124:127], v[176:179], v[32:35], v[148:151]
    ds_read_b64_tr_b16 v[196:197], v13 offset:32
    v_exp_f32 v137, v137
    v_mfma_f32_16x16x32_bf16 v[116:119], v[176:179], v[16:19], v[144:147]
    ds_read_b64_tr_b16 v[198:199], v13 offset:544
    v_cvt_pk_bf16_f32 v225, v130, v131
    s_waitcnt lgkmcnt(9)
    v_mfma_f32_16x16x32_bf16 v[112:115], v[164:167], v[20:23], v[112:115]
    ds_read_b64_tr_b16 v[200:201], v13 offset:64
    v_exp_f32 v138, v138
    v_mfma_f32_16x16x32_bf16 v[120:123], v[164:167], v[36:39], v[120:123]
    ds_read_b64_tr_b16 v[202:203], v13 offset:576
    v_cvt_pk_bf16_f32 v226, v132, v133
    s_waitcnt lgkmcnt(10)
    v_mfma_f32_16x16x32_bf16 v[124:127], v[180:183], v[36:39], v[124:127]
    ds_read_b64_tr_b16 v[204:205], v13 offset:96
    v_exp_f32 v139, v139
    v_mfma_f32_16x16x32_bf16 v[116:119], v[180:183], v[20:23], v[116:119]
    ds_read_b64_tr_b16 v[206:207], v13 offset:608
    v_cvt_pk_bf16_f32 v227, v134, v135
    s_waitcnt lgkmcnt(11)
    v_mfma_f32_16x16x32_bf16 v[112:115], v[168:171], v[24:27], v[112:115]
    ds_read_b64_tr_b16 v[208:209], v13 offset:128
    v_exp_f32 v140, v140
    v_mfma_f32_16x16x32_bf16 v[120:123], v[168:171], v[40:43], v[120:123]
    ds_read_b64_tr_b16 v[210:211], v13 offset:640
    v_exp_f32 v141, v141
    s_waitcnt lgkmcnt(12)
    v_mfma_f32_16x16x32_bf16 v[124:127], v[184:187], v[40:43], v[124:127]
    ds_read_b64_tr_b16 v[212:213], v13 offset:160
    v_cvt_pk_bf16_f32 v228, v136, v137
    v_mfma_f32_16x16x32_bf16 v[116:119], v[184:187], v[24:27], v[116:119]
    ds_read_b64_tr_b16 v[214:215], v13 offset:672
    v_exp_f32 v142, v142
    s_waitcnt lgkmcnt(13)
    v_mfma_f32_16x16x32_bf16 v[112:115], v[172:175], v[28:31], v[112:115]
    ds_read_b64_tr_b16 v[216:217], v13 offset:192
    v_cvt_pk_bf16_f32 v229, v138, v139
    v_mfma_f32_16x16x32_bf16 v[120:123], v[172:175], v[44:47], v[120:123]
    ds_read_b64_tr_b16 v[218:219], v13 offset:704
    v_exp_f32 v143, v143
    s_waitcnt lgkmcnt(14)
    v_mfma_f32_16x16x32_bf16 v[124:127], v[188:191], v[44:47], v[124:127]
    ds_read_b64_tr_b16 v[220:221], v13 offset:224
    v_cvt_pk_bf16_f32 v230, v140, v141
    v_mfma_f32_16x16x32_bf16 v[116:119], v[188:191], v[28:31], v[116:119]
    ds_read_b64_tr_b16 v[222:223], v13 offset:736
    v_cvt_pk_bf16_f32 v231, v142, v143
    s_nop 0
    s_waitcnt lgkmcnt(14)
    v_mfma_f32_16x16x32_bf16 v[48:51], v[192:195], v[224:227], v[48:51]
    v_add_f32 v232, v232, v128
    v_add_f32 v233, v233, v136
    s_add_u32 s34, s96, s86
    s_add_u32 m0, s34, 0
    s_add_u32 s35, s30, 0
    buffer_load_dwordx4 v2, s[44:47], s35 offen nt lds
    v_mfma_f32_16x16x32_bf16 v[80:83], v[192:195], v[228:231], v[80:83]
    v_add_f32 v232, v232, v129
    s_waitcnt lgkmcnt(12)
    v_mfma_f32_16x16x32_bf16 v[84:87], v[196:199], v[228:231], v[84:87]
    v_add_f32 v233, v233, v137
    v_mfma_f32_16x16x32_bf16 v[52:55], v[196:199], v[224:227], v[52:55]
    v_add_f32 v232, v232, v130
    s_add_u32 s34, s97, s87
    s_add_u32 m0, s34, 0
    s_add_u32 s35, s31, 0
    buffer_load_dwordx4 v2, s[48:51], s35 offen nt lds
    s_waitcnt lgkmcnt(10)
    v_mfma_f32_16x16x32_bf16 v[56:59], v[200:203], v[224:227], v[56:59]
    v_add_f32 v233, v233, v138
    v_mfma_f32_16x16x32_bf16 v[88:91], v[200:203], v[228:231], v[88:91]
    v_add_f32 v232, v232, v131
    s_waitcnt lgkmcnt(8)
    v_mfma_f32_16x16x32_bf16 v[92:95], v[204:207], v[228:231], v[92:95]
    v_add_f32 v233, v233, v139
    v_mfma_f32_16x16x32_bf16 v[60:63], v[204:207], v[224:227], v[60:63]
    v_add_f32 v232, v232, v132
    s_add_u32 s34, s96, s86
    s_add_u32 m0, s34, 4224
    s_add_u32 s35, s30, 1024
    buffer_load_dwordx4 v2, s[44:47], s35 offen nt lds
    v_max3_f32 v234, v112, v113, v114
    s_waitcnt lgkmcnt(6)
    v_mfma_f32_16x16x32_bf16 v[64:67], v[208:211], v[224:227], v[64:67]
    v_add_f32 v233, v233, v140
    v_max3_f32 v235, v115, v116, v117
    v_mfma_f32_16x16x32_bf16 v[96:99], v[208:211], v[228:231], v[96:99]
    v_add_f32 v232, v232, v133
    v_max3_f32 v234, v234, v118, v119
    s_waitcnt lgkmcnt(4)
    v_mfma_f32_16x16x32_bf16 v[100:103], v[212:215], v[228:231], v[100:103]
    v_add_f32 v233, v233, v141
    v_max3_f32 v235, v235, v120, v121
    v_mfma_f32_16x16x32_bf16 v[68:71], v[212:215], v[224:227], v[68:71]
    v_add_f32 v232, v232, v134
    s_add_u32 s34, s97, s87
    s_add_u32 m0, s34, 4224
    s_add_u32 s35, s31, 1024
    buffer_load_dwordx4 v2, s[48:51], s35 offen nt lds
    v_max3_f32 v234, v234, v122, v123
    s_waitcnt lgkmcnt(2)
    v_mfma_f32_16x16x32_bf16 v[72:75], v[216:219], v[224:227], v[72:75]
    v_add_f32 v233, v233, v142
    v_max3_f32 v235, v235, v124, v125
    v_mfma_f32_16x16x32_bf16 v[104:107], v[216:219], v[228:231], v[104:107]
    v_add_f32 v232, v232, v135
    v_max3_f32 v234, v234, v126, v127
    s_waitcnt lgkmcnt(0)
    v_mfma_f32_16x16x32_bf16 v[108:111], v[220:223], v[228:231], v[108:111]
    v_add_f32 v233, v233, v143
    v_max_f32 v234, v234, v235
    v_mfma_f32_16x16x32_bf16 v[76:79], v[220:223], v[224:227], v[76:79]
    v_cmp_lt_f32 vcc, s100, v234
    s_mov_b32 s97, s96
    s_mov_b32 s96, s98
    s_mov_b32 s31, s30
    s_cbranch_vccnz L_stub_13
L_back_14:
    s_mov_b32 s85, 0
L_aloop2:
    s_cmp_eq_u32 s94, 0
    s_cbranch_scc1 L_tw_15
    s_waitcnt vmcnt(4)
    s_cmp_eq_u32 s94, 1
    s_cbranch_scc1 L_tw_15
    s_waitcnt vmcnt(4)
L_tw_15:
    s_waitcnt vmcnt(8)
    s_barrier
    s_add_u32 s98, s96, 34304
    s_cmp_eq_u32 s96, 128512
    s_cselect_b32 s98, 0, s98
    s_cmp_eq_u32 s96, 34304
    s_cselect_b32 s98, 94208, s98
    v_add_u32 v11, s98, v10
    v_add_u32 v13, s96, v12
    s_add_u32 s30, s31, 8192
    s_and_b32 s30, s30, 0x1ffff
    ds_read_b128 v[160:163], v11 offset:0
    ds_read_b128 v[176:179], v11 offset:512
    ds_read_b128 v[164:167], v11 offset:64
    ds_read_b128 v[180:183], v11 offset:576
    ds_read_b128 v[168:171], v11 offset:128
    ds_read_b128 v[184:187], v11 offset:640
    ds_read_b128 v[172:175], v11 offset:192
    ds_read_b128 v[188:191], v11 offset:704
    v_exp_f32 v112, v112
    v_exp_f32 v113, v113
    v_exp_f32 v114, v114
    v_exp_f32 v115, v115
    v_exp_f32 v116, v116
    v_exp_f32 v117, v117
    v_exp_f32 v118, v118
    v_exp_f32 v119, v119
    s_waitcnt lgkmcnt(7)
    v_mfma_f32_16x16x32_bf16 v[128:131], v[160:163], v[16:19], v[144:147]
    ds_read_b64_tr_b16 v[192:193], v13 offset:0
    v_exp_f32 v120, v120
    v_mfma_f32_16x16x32_bf16 v[136:139], v[160:163], v[32:35], v[148:151]
    ds_read_b64_tr_b16 v[194:195], v13 offset:512
    v_cvt_pk_bf16_f32 v224, v112, v113
    s_waitcnt lgkmcnt(8)
    v_mfma_f32_16x16x32_bf16 v[140:143], v[176:179], v[32:35], v[148:151]
    ds_read_b64_tr_b16 v[196:197], v13 offset:32
    v_exp_f32 v121, v121
    v_mfma_f32_16x16x32_bf16 v[132:135], v[176:179], v[16:19], v[144:147]
    ds_read_b64_tr_b16 v[198:199], v13 offset:544
    v_cvt_pk_bf16_f32 v225, v114, v115
    s_waitcnt lgkmcnt(9)
    v_mfma_f32_16x16x32_bf16 v[128:131], v[164:167], v[20:23], v[128:131]
    ds_read_b64_tr_b16 v[200:201], v13 offset:64
    v_exp_f32 v122, v122
    v_mfma_f32_16x16x32_bf16 v[136:139], v[164:167], v[36:39], v[136:139]
    ds_read_b64_tr_b16 v[202:203], v13 offset:576
    v_cvt_pk_bf16_f32 v226, v116, v117
    s_waitcnt lgkmcnt(10)
    v_mfma_f32_16x16x32_bf16 v[140:143], v[180:183], v[36:39], v[140:143]
    ds_read_b64_tr_b16 v[204:205], v13 offset:96
    v_exp_f32 v123, v123
    v_mfma_f32_16x16x32_bf16 v[132:135], v[180:183], v[20:23], v[132:135]
    ds_read_b64_tr_b16 v[206:207], v13 offset:608
    v_cvt_pk_bf16_f32 v227, v118, v119
    s_waitcnt lgkmcnt(11)
    v_mfma_f32_16x16x32_bf16 v[128:131], v[168:171], v[24:27], v[128:131]
    ds_read_b64_tr_b16 v[208:209], v13 offset:128
    v_exp_f32 v124, v124
    v_mfma_f32_16x16x32_bf16 v[136:139], v[168:171], v[40:43], v[136:139]
    ds_read_b64_tr_b16 v[210:211], v13 offset:640
    v_exp_f32 v125, v125
    s_waitcnt lgkmcnt(12)
    v_mfma_f32_16x16x32_bf16 v[140:143], v[184:187], v[40:43], v[140:143]
    ds_read_b64_tr_b16 v[212:213], v13 offset:160
    v_cvt_pk_bf16_f32 v228, v120, v121
    v_mfma_f32_16x16x32_bf16 v[132:135], v[184:187], v[24:27], v[132:135]
    ds_read_b64_tr_b16 v[214:215], v13 offset:672
    v_exp_f32 v126, v126
    s_waitcnt lgkmcnt(13)
    v_mfma_f32_16x16x32_bf16 v[128:131], v[172:175], v[28:31], v[128:131]
    ds_read_b64_tr_b16 v[216:217], v13 offset:192
    v_cvt_pk_bf16_f32 v229, v122, v123
    v_mfma_f32_16x16x32_bf16 v[136:139], v[172:175], v[44:47], v[136:139]
    ds_read_b64_tr_b16 v[218:219], v13 offset:704
    v_exp_f32 v127, v127
    s_waitcnt lgkmcnt(14)
    v_mfma_f32_16x16x32_bf16 v[140:143], v[188:191], v[44:47], v[140:143]
    ds_read_b64_tr_b16 v[220:221], v13 offset:224
    v_cvt_pk_bf16_f32 v230, v124, v125
    v_mfma_f32_16x16x32_bf16 v[132:135], v[188:191], v[28:31], v[132:135]
    ds_read_b64_tr_b16 v[222:223], v13 offset:736
    v_cvt_pk_bf16_f32 v231, v126, v127
    s_nop 0
    s_waitcnt lgkmcnt(14)
    v_mfma_f32_16x16x32_bf16 v[48:51], v[192:195], v[224:227], v[48:51]
    v_add_f32 v232, v232, v112
    v_add_f32 v233, v233, v120
    s_add_u32 s34, s96, s86
    s_add_u32 m0, s34, 0
    s_add_u32 s35, s30, 0
    buffer_load_dwordx4 v2, s[44:47], s35 offen nt lds
    v_mfma_f32_16x16x32_bf16 v[80:83], v[192:195], v[228:231], v[80:83]
    v_add_f32 v232, v232, v113
    s_waitcnt lgkmcnt(12)
    v_mfma_f32_16x16x32_bf16 v[84:87], v[196:199], v[228:231], v[84:87]
    v_add_f32 v233, v233, v121
    v_mfma_f32_16x16x32_bf16 v[52:55], v[196:199], v[224:227], v[52:55]
    v_add_f32 v232, v232, v114
    s_add_u32 s34, s97, s87
    s_add_u32 m0, s34, 0
    s_add_u32 s35, s31, 0
    buffer_load_dwordx4 v2, s[48:51], s35 offen nt lds
    s_waitcnt lgkmcnt(10)
    v_mfma_f32_16x16x32_bf16 v[56:59], v[200:203], v[224:227], v[56:59]
    v_add_f32 v233, v233, v122
    v_mfma_f32_16x16x32_bf16 v[88:91], v[200:203], v[228:231], v[88:91]
    v_add_f32 v232, v232, v115
    s_waitcnt lgkmcnt(8)
    v_mfma_f32_16x16x32_bf16 v[92:95], v[204:207], v[228:231], v[92:95]
    v_add_f32 v233, v233, v123
    v_mfma_f32_16x16x32_bf16 v[60:63], v[204:207], v[224:227], v[60:63]
    v_add_f32 v232, v232, v116
    s_add_u32 s34, s96, s86
    s_add_u32 m0, s34, 4224
    s_add_u32 s35, s30, 1024
    buffer_load_dwordx4 v2, s[44:47], s35 offen nt lds
    v_max3_f32 v234, v128, v129, v130
    s_waitcnt lgkmcnt(6)
    v_mfma_f32_16x16x32_bf16 v[64:67], v[208:211], v[224:227], v[64:67]
    v_add_f32 v233, v233, v124
    v_max3_f32 v235, v131, v132, v133
    v_mfma_f32_16x16x32_bf16 v[96:99], v[208:211], v[228:231], v[96:99]
    v_add_f32 v232, v232, v117
    v_max3_f32 v234, v234, v134, v135
    s_waitcnt lgkmcnt(4)
    v_mfma_f32_16x16x32_bf16 v[100:103], v[212:215], v[228:231], v[100:103]
    v_add_f32 v233, v233, v125
    v_max3_f32 v235, v235, v136, v137
    v_mfma_f32_16x16x32_bf16 v[68:71], v[212:215], v[224:227], v[68:71]
    v_add_f32 v232, v232, v118
    s_add_u32 s34, s97, s87
    s_add_u32 m0, s34, 4224
    s_add_u32 s35, s31, 1024
    buffer_load_dwordx4 v2, s[48:51], s35 offen nt lds
    v_max3_f32 v234, v234, v138, v139
    s_waitcnt lgkmcnt(2)
    v_mfma_f32_16x16x32_bf16 v[72:75], v[216:219], v[224:227], v[72:75]
    v_add_f32 v233, v233, v126
    v_max3_f32 v235, v235, v140, v141
    v_mfma_f32_16x16x32_bf16 v[104:107], v[216:219], v[228:231], v[104:107]
    v_add_f32 v232, v232, v119
    v_max3_f32 v234, v234, v142, v143
    s_waitcnt lgkmcnt(0)
    v_mfma_f32_16x16x32_bf16 v[108:111], v[220:223], v[228:231], v[108:111]
    v_add_f32 v233, v233, v127
    v_max_f32 v234, v234, v235
    v_mfma_f32_16x16x32_bf16 v[76:79], v[220:223], v[224:227], v[76:79]
    v_cmp_lt_f32 vcc, s100, v234
    s_mov_b32 s97, s96
    s_mov_b32 s96, s98
    s_mov_b32 s31, s30
    s_cbranch_vccnz L_stub_16
L_back_17:
    s_cmp_eq_u32 s94, 0
    s_cbranch_scc1 L_tw_18
    s_waitcnt vmcnt(4)
    s_cmp_eq_u32 s94, 1
    s_cbranch_scc1 L_tw_18
    s_waitcnt vmcnt(4)
L_tw_18:
    s_waitcnt vmcnt(8)
    s_barrier
    s_add_u32 s98, s96, 34304
    s_cmp_eq_u32 s96, 128512
    s_cselect_b32 s98, 0, s98
    s_cmp_eq_u32 s96, 34304
    s_cselect_b32 s98, 94208, s98
    v_add_u32 v11, s98, v10
    v_add_u32 v13, s96, v12
    s_add_u32 s30, s31, 8192
    s_and_b32 s30, s30, 0x1ffff
    ds_read_b128 v[160:163], v11 offset:0
    ds_read_b128 v[176:179], v11 offset:512
    ds_read_b128 v[164:167], v11 offset:64
    ds_read_b128 v[180:183], v11 offset:576
    ds_read_b128 v[168:171], v11 offset:128
    ds_read_b128 v[184:187], v11 offset:640
    ds_read_b128 v[172:175], v11 offset:192
    ds_read_b128 v[188:191], v11 offset:704
    v_exp_f32 v128, v128
    v_exp_f32 v129, v129
    v_exp_f32 v130, v130
    v_exp_f32 v131, v131
    v_exp_f32 v132, v132
    v_exp_f32 v133, v133
    v_exp_f32 v134, v134
    v_exp_f32 v135, v135
    s_waitcnt lgkmcnt(7)
    v_mfma_f32_16x16x32_bf16 v[112:115], v[160:163], v[16:19], v[144:147]
    ds_read_b64_tr_b16 v[192:193], v13 offset:0
    v_exp_f32 v136, v136
    v_mfma_f32_16x16x32_bf16 v[120:123], v[160:163], v[32:35], v[148:151]
    ds_read_b64_tr_b16 v[194:195], v13 offset:512
    v_cvt_pk_bf16_f32 v224, v128, v129
    s_waitcnt lgkmcnt(8)
    v_mfma_f32_16x16x32_bf16 v[124:127], v[176:179], v[32:35], v[148:151]
    ds_read_b64_tr_b16 v[196:197], v13 offset:32
    v_exp_f32 v137, v137
    v_mfma_f32_16x16x32_bf16 v[116:119], v[176:179], v[16:19], v[144:147]
    ds_read_b64_tr_b16 v[198:199], v13 offset:544
    v_cvt_pk_bf16_f32 v225, v130, v131
    s_waitcnt lgkmcnt(9)
    v_mfma_f32_16x16x32_bf16 v[112:115], v[164:167], v[20:23], v[112:115]
    ds_read_b64_tr_b16 v[200:201], v13 offset:64
    v_exp_f32 v138, v138
    v_mfma_f32_16x16x32_bf16 v[120:123], v[164:167], v[36:39], v[120:123]
    ds_read_b64_tr_b16 v[202:203], v13 offset:576
    v_cvt_pk_bf16_f32 v226, v132, v133
    s_waitcnt lgkmcnt(10)
    v_mfma_f32_16x16x32_bf16 v[124:127], v[180:183], v[36:39], v[124:127]
    ds_read_b64_tr_b16 v[204:205], v13 offset:96
    v_exp_f32 v139, v139
    v_mfma_f32_16x16x32_bf16 v[116:119], v[180:183], v[20:23], v[116:119]
    ds_read_b64_tr_b16 v[206:207], v13 offset:608
    v_cvt_pk_bf16_f32 v227, v134, v135
    s_waitcnt lgkmcnt(11)
    v_mfma_f32_16x16x32_bf16 v[112:115], v[168:171], v[24:27], v[112:115]
    ds_read_b64_tr_b16 v[208:209], v13 offset:128
    v_exp_f32 v140, v140
    v_mfma_f32_16x16x32_bf16 v[120:123], v[168:171], v[40:43], v[120:123]
    ds_read_b64_tr_b16 v[210:211], v13 offset:640
    v_exp_f32 v141, v141
    s_waitcnt lgkmcnt(12)
    v_mfma_f32_16x16x32_bf16 v[124:127], v[184:187], v[40:43], v[124:127]
    ds_read_b64_tr_b16 v[212:213], v13 offset:160
    v_cvt_pk_bf16_f32 v228, v136, v137
    v_mfma_f32_16x16x32_bf16 v[116:119], v[184:187], v[24:27], v[116:119]
    ds_read_b64_tr_b16 v[214:215], v13 offset:672
    v_exp_f32 v142, v142
    s_waitcnt lgkmcnt(13)
    v_mfma_f32_16x16x32_bf16 v[112:115], v[172:175], v[28:31], v[112:115]
    ds_read_b64_tr_b16 v[216:217], v13 offset:192
    v_cvt_pk_bf16_f32 v229, v138, v139
    v_mfma_f32_16x16x32_bf16 v[120:123], v[172:175], v[44:47], v[120:123]
    ds_read_b64_tr_b16 v[218:219], v13 offset:704
    v_exp_f32 v143, v143
    s_waitcnt lgkmcnt(14)
    v_mfma_f32_16x16x32_bf16 v[124:127], v[188:191], v[44:47], v[124:127]
    ds_read_b64_tr_b16 v[220:221], v13 offset:224
    v_cvt_pk_bf16_f32 v230, v140, v141
    v_mfma_f32_16x16x32_bf16 v[116:119], v[188:191], v[28:31], v[116:119]
    ds_read_b64_tr_b16 v[222:223], v13 offset:736
    v_cvt_pk_bf16_f32 v231, v142, v143
    s_nop 0
    s_waitcnt lgkmcnt(14)
    v_mfma_f32_16x16x32_bf16 v[48:51], v[192:195], v[224:227], v[48:51]
    v_add_f32 v232, v232, v128
    v_add_f32 v233, v233, v136
    s_add_u32 s34, s96, s86
    s_add_u32 m0, s34, 0
    s_add_u32 s35, s30, 0
    buffer_load_dwordx4 v2, s[44:47], s35 offen nt lds
    v_mfma_f32_16x16x32_bf16 v[80:83], v[192:195], v[228:231], v[80:83]
    v_add_f32 v232, v232, v129
    s_waitcnt lgkmcnt(12)
    v_mfma_f32_16x16x32_bf16 v[84:87], v[196:199], v[228:231], v[84:87]
    v_add_f32 v233, v233, v137
    v_mfma_f32_16x16x32_bf16 v[52:55], v[196:199], v[224:227], v[52:55]
    v_add_f32 v232, v232, v130
    s_add_u32 s34, s97, s87
    s_add_u32 m0, s34, 0
    s_add_u32 s35, s31, 0
    buffer_load_dwordx4 v2, s[48:51], s35 offen nt lds
    s_waitcnt lgkmcnt(10)
    v_mfma_f32_16x16x32_bf16 v[56:59], v[200:203], v[224:227], v[56:59]
    v_add_f32 v233, v233, v138
    v_mfma_f32_16x16x32_bf16 v[88:91], v[200:203], v[228:231], v[88:91]
    v_add_f32 v232, v232, v131
    s_waitcnt lgkmcnt(8)
    v_mfma_f32_16x16x32_bf16 v[92:95], v[204:207], v[228:231], v[92:95]
    v_add_f32 v233, v233, v139
    v_mfma_f32_16x16x32_bf16 v[60:63], v[204:207], v[224:227], v[60:63]
    v_add_f32 v232, v232, v132
    s_add_u32 s34, s96, s86
    s_add_u32 m0, s34, 4224
    s_add_u32 s35, s30, 1024
    buffer_load_dwordx4 v2, s[44:47], s35 offen nt lds
    v_max3_f32 v234, v112, v113, v114
    s_waitcnt lgkmcnt(6)
    v_mfma_f32_16x16x32_bf16 v[64:67], v[208:211], v[224:227], v[64:67]
    v_add_f32 v233, v233, v140
    v_max3_f32 v235, v115, v116, v117
    v_mfma_f32_16x16x32_bf16 v[96:99], v[208:211], v[228:231], v[96:99]
    v_add_f32 v232, v232, v133
    v_max3_f32 v234, v234, v118, v119
    s_waitcnt lgkmcnt(4)
    v_mfma_f32_16x16x32_bf16 v[100:103], v[212:215], v[228:231], v[100:103]
    v_add_f32 v233, v233, v141
    v_max3_f32 v235, v235, v120, v121
    v_mfma_f32_16x16x32_bf16 v[68:71], v[212:215], v[224:227], v[68:71]
    v_add_f32 v232, v232, v134
    s_add_u32 s34, s97, s87
    s_add_u32 m0, s34, 4224
    s_add_u32 s35, s31, 1024
    buffer_load_dwordx4 v2, s[48:51], s35 offen nt lds
    v_max3_f32 v234, v234, v122, v123
    s_waitcnt lgkmcnt(2)
    v_mfma_f32_16x16x32_bf16 v[72:75], v[216:219], v[224:227], v[72:75]
    v_add_f32 v233, v233, v142
    v_max3_f32 v235, v235, v124, v125
    v_mfma_f32_16x16x32_bf16 v[104:107], v[216:219], v[228:231], v[104:107]
    v_add_f32 v232, v232, v135
    v_max3_f32 v234, v234, v126, v127
    s_waitcnt lgkmcnt(0)
    v_mfma_f32_16x16x32_bf16 v[108:111], v[220:223], v[228:231], v[108:111]
    v_add_f32 v233, v233, v143
    v_max_f32 v234, v234, v235
    v_mfma_f32_16x16x32_bf16 v[76:79], v[220:223], v[224:227], v[76:79]
    v_cmp_lt_f32 vcc, s100, v234
    s_mov_b32 s97, s96
    s_mov_b32 s96, s98
    s_mov_b32 s31, s30
    s_cbranch_vccnz L_stub_19
L_back_20:
    s_add_u32 s85, s85, 1
    s_cmp_lt_u32 s85, 5
    s_cbranch_scc1 L_aloop2
    s_waitcnt vmcnt(8)
    s_barrier
    s_add_u32 s98, s96, 34304
    s_cmp_eq_u32 s96, 128512
    s_cselect_b32 s98, 0, s98
    s_cmp_eq_u32 s96, 34304
    s_cselect_b32 s98, 94208, s98
    v_add_u32 v11, s98, v10
    v_add_u32 v13, s96, v12
    s_add_u32 s30, s31, 8192
    s_and_b32 s30, s30, 0x1ffff
    ds_read_b128 v[160:163], v11 offset:0
    ds_read_b128 v[176:179], v11 offset:512
    ds_read_b128 v[164:167], v11 offset:64
    ds_read_b128 v[180:183], v11 offset:576
    ds_read_b128 v[168:171], v11 offset:128
    ds_read_b128 v[184:187], v11 offset:640
    ds_read_b128 v[172:175], v11 offset:192
    ds_read_b128 v[188:191], v11 offset:704
    v_exp_f32 v112, v112
    v_exp_f32 v113, v113
    v_exp_f32 v114, v114
    v_exp_f32 v115, v115
    v_exp_f32 v116, v116
    v_exp_f32 v117, v117
    v_exp_f32 v118, v118
    v_exp_f32 v119, v119
    s_waitcnt lgkmcnt(7)
    v_mfma_f32_16x16x32_bf16 v[128:131], v[160:163], v[16:19], v[144:147]
    ds_read_b64_tr_b16 v[192:193], v13 offset:0
    v_exp_f32 v120, v120
    v_mfma_f32_16x16x32_bf16 v[136:139], v[160:163], v[32:35], v[148:151]
    ds_read_b64_tr_b16 v[194:195], v13 offset:512
    v_cvt_pk_bf16_f32 v224, v112, v113
    s_waitcnt lgkmcnt(8)
    v_mfma_f32_16x16x32_bf16 v[140:143], v[176:179], v[32:35], v[148:151]
    ds_read_b64_tr_b16 v[196:197], v13 offset:32
    v_exp_f32 v121, v121
    v_mfma_f32_16x16x32_bf16 v[132:135], v[176:179], v[16:19], v[144:147]
    ds_read_b64_tr_b16 v[198:199], v13 offset:544
    v_cvt_pk_bf16_f32 v225, v114, v115
    s_waitcnt lgkmcnt(9)
    v_mfma_f32_16x16x32_bf16 v[128:131], v[164:167], v[20:23], v[128:131]
    ds_read_b64_tr_b16 v[200:201], v13 offset:64
    v_exp_f32 v122, v122
    v_mfma_f32_16x16x32_bf16 v[136:139], v[164:167], v[36:39], v[136:139]
    ds_read_b64_tr_b16 v[202:203], v13 offset:576
    v_cvt_pk_bf16_f32 v226, v116, v117
    s_waitcnt lgkmcnt(10)
    v_mfma_f32_16x16x32_bf16 v[140:143], v[180:183], v[36:39], v[140:143]
    ds_read_b64_tr_b16 v[204:205], v13 offset:96
    v_exp_f32 v123, v123
    v_mfma_f32_16x16x32_bf16 v[132:135], v[180:183], v[20:23], v[132:135]
    ds_read_b64_tr_b16 v[206:207], v13 offset:608
    v_cvt_pk_bf16_f32 v227, v118, v119
    s_waitcnt lgkmcnt(11)
    v_mfma_f32_16x16x32_bf16 v[128:131], v[168:171], v[24:27], v[128:131]
    ds_read_b64_tr_b16 v[208:209], v13 offset:128
    v_exp_f32 v124, v124
    v_mfma_f32_16x16x32_bf16 v[136:139], v[168:171], v[40:43], v[136:139]
    ds_read_b64_tr_b16 v[210:211], v13 offset:640
    v_exp_f32 v125, v125
    s_waitcnt lgkmcnt(12)
    v_mfma_f32_16x16x32_bf16 v[140:143], v[184:187], v[40:43], v[140:143]
    ds_read_b64_tr_b16 v[212:213], v13 offset:160
    v_cvt_pk_bf16_f32 v228, v120, v121
    v_mfma_f32_16x16x32_bf16 v[132:135], v[184:187], v[24:27], v[132:135]
    ds_read_b64_tr_b16 v[214:215], v13 offset:672
    v_exp_f32 v126, v126
    s_waitcnt lgkmcnt(13)
    v_mfma_f32_16x16x32_bf16 v[128:131], v[172:175], v[28:31], v[128:131]
    ds_read_b64_tr_b16 v[216:217], v13 offset:192
    v_cvt_pk_bf16_f32 v229, v122, v123
    v_mfma_f32_16x16x32_bf16 v[136:139], v[172:175], v[44:47], v[136:139]
    ds_read_b64_tr_b16 v[218:219], v13 offset:704
    v_exp_f32 v127, v127
    s_waitcnt lgkmcnt(14)
    v_mfma_f32_16x16x32_bf16 v[140:143], v[188:191], v[44:47], v[140:143]
    ds_read_b64_tr_b16 v[220:221], v13 offset:224
    v_cvt_pk_bf16_f32 v230, v124, v125
    v_mfma_f32_16x16x32_bf16 v[132:135], v[188:191], v[28:31], v[132:135]
    ds_read_b64_tr_b16 v[222:223], v13 offset:736
    v_cvt_pk_bf16_f32 v231, v126, v127
    s_nop 0
    s_waitcnt lgkmcnt(14)
    v_mfma_f32_16x16x32_bf16 v[48:51], v[192:195], v[224:227], v[48:51]
    v_add_f32 v232, v232, v112
    v_add_f32 v233, v233, v120
    s_add_u32 s34, s97, s87
    s_add_u32 m0, s34, 0
    s_add_u32 s35, s31, 0
    buffer_load_dwordx4 v2, s[48:51], s35 offen nt lds
    v_mfma_f32_16x16x32_bf16 v[80:83], v[192:195], v[228:231], v[80:83]
    v_add_f32 v232, v232, v113
    s_waitcnt lgkmcnt(12)
    v_mfma_f32_16x16x32_bf16 v[84:87], v[196:199], v[228:231], v[84:87]
    v_add_f32 v233, v233, v121
    v_mfma_f32_16x16x32_bf16 v[52:55], v[196:199], v[224:227], v[52:55]
    v_add_f32 v232, v232, v114
    s_add_u32 s34, s97, s87
    s_add_u32 m0, s34, 4224
    s_add_u32 s35, s31, 1024
    buffer_load_dwordx4 v2, s[48:51], s35 offen nt lds
    s_waitcnt lgkmcnt(10)
    v_mfma_f32_16x16x32_bf16 v[56:59], v[200:203], v[224:227], v[56:59]
    v_add_f32 v233, v233, v122
    v_mfma_f32_16x16x32_bf16 v[88:91], v[200:203], v[228:231], v[88:91]
    v_add_f32 v232, v232, v115
    s_waitcnt lgkmcnt(8)
    v_mfma_f32_16x16x32_bf16 v[92:95], v[204:207], v[228:231], v[92:95]
    v_add_f32 v233, v233, v123
    v_mfma_f32_16x16x32_bf16 v[60:63], v[204:207], v[224:227], v[60:63]
    v_add_f32 v232, v232, v116
    buffer_load_dword v236, v4, s[40:43], 0 offen sc1
    v_max3_f32 v234, v128, v129, v130
    s_waitcnt lgkmcnt(6)
    v_mfma_f32_16x16x32_bf16 v[64:67], v[208:211], v[224:227], v[64:67]
    v_add_f32 v233, v233, v124
    v_max3_f32 v235, v131, v132, v133
    v_mfma_f32_16x16x32_bf16 v[96:99], v[208:211], v[228:231], v[96:99]
    v_add_f32 v232, v232, v117
    v_max3_f32 v234, v234, v134, v135
    s_waitcnt lgkmcnt(4)
    v_mfma_f32_16x16x32_bf16 v[100:103], v[212:215], v[228:231], v[100:103]
    v_add_f32 v233, v233, v125
    v_max3_f32 v235, v235, v136, v137
    v_mfma_f32_16x16x32_bf16 v[68:71], v[212:215], v[224:227], v[68:71]
    v_add_f32 v232, v232, v118
    s_cmp_lg_u32 s3, 1
    s_cbranch_scc1 L_wt_21
    s_add_u32 s6, s82, 0
    s_and_b32 s6, s6, 3
    s_lshl_b32 s6, s6, 1
    s_add_u32 s6, s6, 1
    s_lshl_b32 s6, s6, 18
    buffer_load_dword v237, v3, s[56:59], s6 offen
L_wt_21:
    v_max3_f32 v234, v234, v138, v139
    s_waitcnt lgkmcnt(2)
    v_mfma_f32_16x16x32_bf16 v[72:75], v[216:219], v[224:227], v[72:75]
    v_add_f32 v233, v233, v126
    v_max3_f32 v235, v235, v140, v141
    v_mfma_f32_16x16x32_bf16 v[104:107], v[216:219], v[228:231], v[104:107]
    v_add_f32 v232, v232, v119
    v_max3_f32 v234, v234, v142, v143
    s_waitcnt lgkmcnt(0)
    v_mfma_f32_16x16x32_bf16 v[108:111], v[220:223], v[228:231], v[108:111]
    v_add_f32 v233, v233, v127
    v_max_f32 v234, v234, v235
    v_mfma_f32_16x16x32_bf16 v[76:79], v[220:223], v[224:227], v[76:79]
    v_cmp_lt_f32 vcc, s100, v234
    s_mov_b32 s97, s96
    s_mov_b32 s96, s98
    s_mov_b32 s31, s30
    s_cbranch_vccnz L_stub_22
L_back_23:
    s_add_u32 s5, s82, 0
    s_and_b32 s5, s5, 3
    s_lshl_b32 s5, s5, 1
    s_add_u32 s5, s5, 0
    s_lshl_b32 s5, s5, 18
    s_lshr_b32 s34, s3, 2
    s_lshl_b32 s35, s34, 16
    s_add_u32 s5, s5, s35
    s_lshl_b32 s86, s84, 10
    s_add_u32 s86, s86, 94208
    s_lshl_b32 s35, s34, 14
    s_add_u32 s87, s86, s35
    s_waitcnt vmcnt(6)
    s_barrier
    s_add_u32 s98, s96, 34304
    s_cmp_eq_u32 s96, 128512
    s_cselect_b32 s98, 0, s98
    s_cmp_eq_u32 s96, 34304
    s_cselect_b32 s98, 94208, s98
    v_add_u32 v11, s98, v10
    v_add_u32 v13, s96, v12
    s_add_u32 s30, s31, 8192
    s_and_b32 s30, s30, 0x1ffff
    ds_read_b128 v[160:163], v11 offset:0
    ds_read_b128 v[176:179], v11 offset:512
    ds_read_b128 v[164:167], v11 offset:64
    ds_read_b128 v[180:183], v11 offset:576
    ds_read_b128 v[168:171], v11 offset:128
    ds_read_b128 v[184:187], v11 offset:640
    ds_read_b128 v[172:175], v11 offset:192
    ds_read_b128 v[188:191], v11 offset:704
    v_exp_f32 v128, v128
    v_exp_f32 v129, v129
    v_exp_f32 v130, v130
    v_exp_f32 v131, v131
    v_exp_f32 v132, v132
    v_exp_f32 v133, v133
    v_exp_f32 v134, v134
    v_exp_f32 v135, v135
    s_waitcnt lgkmcnt(7)
    v_mfma_f32_16x16x32_bf16 v[112:115], v[160:163], v[16:19], v[144:147]
    ds_read_b64_tr_b16 v[192:193], v13 offset:0
    v_exp_f32 v136, v136
    v_mfma_f32_16x16x32_bf16 v[120:123], v[160:163], v[32:35], v[148:151]
    ds_read_b64_tr_b16 v[194:195], v13 offset:512
    v_cvt_pk_bf16_f32 v224, v128, v129
    s_waitcnt lgkmcnt(8)
    v_mfma_f32_16x16x32_bf16 v[124:127], v[176:179], v[32:35], v[148:151]
    ds_read_b64_tr_b16 v[196:197], v13 offset:32
    v_exp_f32 v137, v137
    v_mfma_f32_16x16x32_bf16 v[116:119], v[176:179], v[16:19], v[144:147]
    ds_read_b64_tr_b16 v[198:199], v13 offset:544
    v_cvt_pk_bf16_f32 v225, v130, v131
    s_waitcnt lgkmcnt(9)
    v_mfma_f32_16x16x32_bf16 v[112:115], v[164:167], v[20:23], v[112:115]
    ds_read_b64_tr_b16 v[200:201], v13 offset:64
    v_exp_f32 v138, v138
    v_mfma_f32_16x16x32_bf16 v[120:123], v[164:167], v[36:39], v[120:123]
    ds_read_b64_tr_b16 v[202:203], v13 offset:576
    v_cvt_pk_bf16_f32 v226, v132, v133
    s_waitcnt lgkmcnt(10)
    v_mfma_f32_16x16x32_bf16 v[124:127], v[180:183], v[36:39], v[124:127]
    ds_read_b64_tr_b16 v[204:205], v13 offset:96
    v_exp_f32 v139, v139
    v_mfma_f32_16x16x32_bf16 v[116:119], v[180:183], v[20:23], v[116:119]
    ds_read_b64_tr_b16 v[206:207], v13 offset:608
    v_cvt_pk_bf16_f32 v227, v134, v135
    s_waitcnt lgkmcnt(11)
    v_mfma_f32_16x16x32_bf16 v[112:115], v[168:171], v[24:27], v[112:115]
    ds_read_b64_tr_b16 v[208:209], v13 offset:128
    v_exp_f32 v140, v140
    v_mfma_f32_16x16x32_bf16 v[120:123], v[168:171], v[40:43], v[120:123]
    ds_read_b64_tr_b16 v[210:211], v13 offset:640
    v_exp_f32 v141, v141
    s_waitcnt lgkmcnt(12)
    v_mfma_f32_16x16x32_bf16 v[124:127], v[184:187], v[40:43], v[124:127]
    ds_read_b64_tr_b16 v[212:213], v13 offset:160
    v_cvt_pk_bf16_f32 v228, v136, v137
    v_mfma_f32_16x16x32_bf16 v[116:119], v[184:187], v[24:27], v[116:119]
    ds_read_b64_tr_b16 v[214:215], v13 offset:672
    v_exp_f32 v142, v142
    s_waitcnt lgkmcnt(13)
    v_mfma_f32_16x16x32_bf16 v[112:115], v[172:175], v[28:31], v[112:115]
    ds_read_b64_tr_b16 v[216:217], v13 offset:192
    v_cvt_pk_bf16_f32 v229, v138, v139
    v_mfma_f32_16x16x32_bf16 v[120:123], v[172:175], v[44:47], v[120:123]
    ds_read_b64_tr_b16 v[218:219], v13 offset:704
    v_exp_f32 v143, v143
    s_waitcnt lgkmcnt(14)
    v_mfma_f32_16x16x32_bf16 v[124:127], v[188:191], v[44:47], v[124:127]
    ds_read_b64_tr_b16 v[220:221], v13 offset:224
    v_cvt_pk_bf16_f32 v230, v140, v141
    v_mfma_f32_16x16x32_bf16 v[116:119], v[188:191], v[28:31], v[116:119]
    ds_read_b64_tr_b16 v[222:223], v13 offset:736
    v_cvt_pk_bf16_f32 v231, v142, v143
    s_nop 0
    s_waitcnt lgkmcnt(14)
    v_mfma_f32_16x16x32_bf16 v[48:51], v[192:195], v[224:227], v[48:51]
    v_add_f32 v232, v232, v128
    v_add_f32 v233, v233, v136
    s_add_u32 m0, s87, 0
    s_add_u32 s35, s5, 0
    buffer_load_dwordx4 v15, s[56:59], s35 offen lds
    v_mfma_f32_16x16x32_bf16 v[80:83], v[192:195], v[228:231], v[80:83]
    v_add_f32 v232, v232, v129
    s_waitcnt lgkmcnt(12)
    v_mfma_f32_16x16x32_bf16 v[84:87], v[196:199], v[228:231], v[84:87]
    v_add_f32 v233, v233, v137
    v_mfma_f32_16x16x32_bf16 v[52:55], v[196:199], v[224:227], v[52:55]
    v_add_f32 v232, v232, v130
    s_add_u32 m0, s87, 4096
    s_add_u32 s35, s5, 16384
    buffer_load_dwordx4 v15, s[56:59], s35 offen lds
    s_waitcnt lgkmcnt(10)
    v_mfma_f32_16x16x32_bf16 v[56:59], v[200:203], v[224:227], v[56:59]
    v_add_f32 v233, v233, v138
    v_mfma_f32_16x16x32_bf16 v[88:91], v[200:203], v[228:231], v[88:91]
    v_add_f32 v232, v232, v131
    s_waitcnt lgkmcnt(8)
    v_mfma_f32_16x16x32_bf16 v[92:95], v[204:207], v[228:231], v[92:95]
    v_add_f32 v233, v233, v139
    v_mfma_f32_16x16x32_bf16 v[60:63], v[204:207], v[224:227], v[60:63]
    v_add_f32 v232, v232, v132
    s_add_u32 m0, s87, 8192
    s_add_u32 s35, s5, 32768
    buffer_load_dwordx4 v15, s[56:59], s35 offen lds
    v_max3_f32 v234, v112, v113, v114
    s_waitcnt lgkmcnt(6)
    v_mfma_f32_16x16x32_bf16 v[64:67], v[208:211], v[224:227], v[64:67]
    v_add_f32 v233, v233, v140
    v_max3_f32 v235, v115, v116, v117
    v_mfma_f32_16x16x32_bf16 v[96:99], v[208:211], v[228:231], v[96:99]
    v_add_f32 v232, v232, v133
    v_max3_f32 v234, v234, v118, v119
    s_waitcnt lgkmcnt(4)
    v_mfma_f32_16x16x32_bf16 v[100:103], v[212:215], v[228:231], v[100:103]
    v_add_f32 v233, v233, v141
    v_max3_f32 v235, v235, v120, v121
    v_mfma_f32_16x16x32_bf16 v[68:71], v[212:215], v[224:227], v[68:71]
    v_add_f32 v232, v232, v134
    s_add_u32 m0, s87, 12288
    s_add_u32 s35, s5, 49152
    buffer_load_dwordx4 v15, s[56:59], s35 offen lds
    s_cmp_lg_u32 s3, 2
    s_cbranch_scc1 L_wt_24
    s_add_u32 s6, s82, 1
    s_and_b32 s6, s6, 3
    s_lshl_b32 s6, s6, 1
    s_add_u32 s6, s6, 0
    s_lshl_b32 s6, s6, 18
    buffer_load_dword v237, v3, s[56:59], s6 offen
L_wt_24:
    s_cmp_lg_u32 s3, 3
    s_cbranch_scc1 L_wt_25
    s_add_u32 s6, s82, 2
    s_and_b32 s6, s6, 3
    s_lshl_b32 s6, s6, 1
    s_add_u32 s6, s6, 0
    s_lshl_b32 s6, s6, 18
    buffer_load_dword v237, v3, s[56:59], s6 offen
L_wt_25:
    v_max3_f32 v234, v234, v122, v123
    s_waitcnt lgkmcnt(2)
    v_mfma_f32_16x16x32_bf16 v[72:75], v[216:219], v[224:227], v[72:75]
    v_add_f32 v233, v233, v142
    v_max3_f32 v235, v235, v124, v125
    v_mfma_f32_16x16x32_bf16 v[104:107], v[216:219], v[228:231], v[104:107]
    v_add_f32 v232, v232, v135
    v_max3_f32 v234, v234, v126, v127
    s_waitcnt lgkmcnt(0)
    v_mfma_f32_16x16x32_bf16 v[108:111], v[220:223], v[228:231], v[108:111]
    v_add_f32 v233, v233, v143
    v_max_f32 v234, v234, v235
    v_mfma_f32_16x16x32_bf16 v[76:79], v[220:223], v[224:227], v[76:79]
    v_cmp_lt_f32 vcc, s100, v234
    s_mov_b32 s97, s96
    s_mov_b32 s96, s98
    s_mov_b32 s31, s30
    s_cbranch_vccnz L_stub_26
L_back_27:
    s_waitcnt vmcnt(6)
    s_barrier
    s_add_u32 s98, s96, 34304
    s_cmp_eq_u32 s96, 128512
    s_cselect_b32 s98, 0, s98
    s_cmp_eq_u32 s96, 34304
    s_cselect_b32 s98, 94208, s98
    v_add_u32 v11, s98, v10
    v_add_u32 v13, s96, v12
    s_add_u32 s30, s31, 8192
    s_and_b32 s30, s30, 0x1ffff
    ds_read_b128 v[160:163], v11 offset:0
    ds_read_b128 v[176:179], v11 offset:512
    ds_read_b128 v[164:167], v11 offset:64
    ds_read_b128 v[180:183], v11 offset:576
    ds_read_b128 v[168:171], v11 offset:128
    ds_read_b128 v[184:187], v11 offset:640
    ds_read_b128 v[172:175], v11 offset:192
    ds_read_b128 v[188:191], v11 offset:704
    v_exp_f32 v112, v112
    v_exp_f32 v113, v113
    v_exp_f32 v114, v114
    v_exp_f32 v115, v115
    v_exp_f32 v116, v116
    v_exp_f32 v117, v117
    v_exp_f32 v118, v118
    v_exp_f32 v119, v119
    s_waitcnt lgkmcnt(7)
    v_mfma_f32_16x16x32_bf16 v[128:131], v[160:163], v[16:19], v[144:147]
    ds_read_b64_tr_b16 v[192:193], v13 offset:0
    v_exp_f32 v120, v120
    v_mfma_f32_16x16x32_bf16 v[136:139], v[160:163], v[32:35], v[148:151]
    ds_read_b64_tr_b16 v[194:195], v13 offset:512
    v_cvt_pk_bf16_f32 v224, v112, v113
    s_waitcnt lgkmcnt(8)
    v_mfma_f32_16x16x32_bf16 v[140:143], v[176:179], v[32:35], v[148:151]
    ds_read_b64_tr_b16 v[196:197], v13 offset:32
    v_exp_f32 v121, v121
    v_mfma_f32_16x16x32_bf16 v[132:135], v[176:179], v[16:19], v[144:147]
    ds_read_b64_tr_b16 v[198:199], v13 offset:544
    v_cvt_pk_bf16_f32 v225, v114, v115
    s_waitcnt lgkmcnt(9)
    v_mfma_f32_16x16x32_bf16 v[128:131], v[164:167], v[20:23], v[128:131]
    ds_read_b64_tr_b16 v[200:201], v13 offset:64
    v_exp_f32 v122, v122
    v_mfma_f32_16x16x32_bf16 v[136:139], v[164:167], v[36:39], v[136:139]
    ds_read_b64_tr_b16 v[202:203], v13 offset:576
    v_cvt_pk_bf16_f32 v226, v116, v117
    s_waitcnt lgkmcnt(10)
    v_mfma_f32_16x16x32_bf16 v[140:143], v[180:183], v[36:39], v[140:143]
    ds_read_b64_tr_b16 v[204:205], v13 offset:96
    v_exp_f32 v123, v123
    v_mfma_f32_16x16x32_bf16 v[132:135], v[180:183], v[20:23], v[132:135]
    ds_read_b64_tr_b16 v[206:207], v13 offset:608
    v_cvt_pk_bf16_f32 v227, v118, v119
    s_waitcnt lgkmcnt(11)
    v_mfma_f32_16x16x32_bf16 v[128:131], v[168:171], v[24:27], v[128:131]
    ds_read_b64_tr_b16 v[208:209], v13 offset:128
    v_exp_f32 v124, v124
    v_mfma_f32_16x16x32_bf16 v[136:139], v[168:171], v[40:43], v[136:139]
    ds_read_b64_tr_b16 v[210:211], v13 offset:640
    v_exp_f32 v125, v125
    s_waitcnt lgkmcnt(12)
    v_mfma_f32_16x16x32_bf16 v[140:143], v[184:187], v[40:43], v[140:143]
    ds_read_b64_tr_b16 v[212:213], v13 offset:160
    v_cvt_pk_bf16_f32 v228, v120, v121
    v_mfma_f32_16x16x32_bf16 v[132:135], v[184:187], v[24:27], v[132:135]
    ds_read_b64_tr_b16 v[214:215], v13 offset:672
    v_exp_f32 v126, v126
    s_waitcnt lgkmcnt(13)
    v_mfma_f32_16x16x32_bf16 v[128:131], v[172:175], v[28:31], v[128:131]
    ds_read_b64_tr_b16 v[216:217], v13 offset:192
    v_cvt_pk_bf16_f32 v229, v122, v123
    v_mfma_f32_16x16x32_bf16 v[136:139], v[172:175], v[44:47], v[136:139]
    ds_read_b64_tr_b16 v[218:219], v13 offset:704
    v_exp_f32 v127, v127
    s_waitcnt lgkmcnt(14)
    v_mfma_f32_16x16x32_bf16 v[140:143], v[188:191], v[44:47], v[140:143]
    ds_read_b64_tr_b16 v[220:221], v13 offset:224
    v_cvt_pk_bf16_f32 v230, v124, v125
    v_mfma_f32_16x16x32_bf16 v[132:135], v[188:191], v[28:31], v[132:135]
    ds_read_b64_tr_b16 v[222:223], v13 offset:736
    v_cvt_pk_bf16_f32 v231, v126, v127
    s_nop 0
    s_waitcnt lgkmcnt(14)
    v_mfma_f32_16x16x32_bf16 v[48:51], v[192:195], v[224:227], v[48:51]
    v_add_f32 v232, v232, v112
    v_add_f32 v233, v233, v120
    s_add_u32 m0, s87, 32768
    s_add_u32 s35, s5, 131072
    buffer_load_dwordx4 v15, s[56:59], s35 offen lds
    v_mfma_f32_16x16x32_bf16 v[80:83], v[192:195], v[228:231], v[80:83]
    v_add_f32 v232, v232, v113
    s_waitcnt lgkmcnt(12)
    v_mfma_f32_16x16x32_bf16 v[84:87], v[196:199], v[228:231], v[84:87]
    v_add_f32 v233, v233, v121
    v_mfma_f32_16x16x32_bf16 v[52:55], v[196:199], v[224:227], v[52:55]
    v_add_f32 v232, v232, v114
    s_add_u32 m0, s87, 36864
    s_add_u32 s35, s5, 147456
    buffer_load_dwordx4 v15, s[56:59], s35 offen lds
    s_waitcnt lgkmcnt(10)
    v_mfma_f32_16x16x32_bf16 v[56:59], v[200:203], v[224:227], v[56:59]
    v_add_f32 v233, v233, v122
    v_mfma_f32_16x16x32_bf16 v[88:91], v[200:203], v[228:231], v[88:91]
    v_add_f32 v232, v232, v115
    s_waitcnt lgkmcnt(8)
    v_mfma_f32_16x16x32_bf16 v[92:95], v[204:207], v[228:231], v[92:95]
    v_add_f32 v233, v233, v123
    v_mfma_f32_16x16x32_bf16 v[60:63], v[204:207], v[224:227], v[60:63]
    v_add_f32 v232, v232, v116
    s_add_u32 m0, s87, 40960
    s_add_u32 s35, s5, 163840
    buffer_load_dwordx4 v15, s[56:59], s35 offen lds
    v_max3_f32 v234, v128, v129, v130
    s_waitcnt lgkmcnt(6)
    v_mfma_f32_16x16x32_bf16 v[64:67], v[208:211], v[224:227], v[64:67]
    v_add_f32 v233, v233, v124
    v_max3_f32 v235, v131, v132, v133
    v_mfma_f32_16x16x32_bf16 v[96:99], v[208:211], v[228:231], v[96:99]
    v_add_f32 v232, v232, v117
    v_max3_f32 v234, v234, v134, v135
    s_waitcnt lgkmcnt(4)
    v_mfma_f32_16x16x32_bf16 v[100:103], v[212:215], v[228:231], v[100:103]
    v_add_f32 v233, v233, v125
    v_max3_f32 v235, v235, v136, v137
    v_mfma_f32_16x16x32_bf16 v[68:71], v[212:215], v[224:227], v[68:71]
    v_add_f32 v232, v232, v118
    s_add_u32 m0, s87, 45056
    s_add_u32 s35, s5, 180224
    buffer_load_dwordx4 v15, s[56:59], s35 offen lds
    s_cmp_lg_u32 s3, 4
    s_cbranch_scc1 L_wt_28
    s_add_u32 s6, s82, 3
    s_and_b32 s6, s6, 3
    s_lshl_b32 s6, s6, 1
    s_add_u32 s6, s6, 0
    s_lshl_b32 s6, s6, 18
    buffer_load_dword v237, v3, s[56:59], s6 offen
L_wt_28:
    s_cmp_lg_u32 s3, 5
    s_cbranch_scc1 L_wt_29
    s_add_u32 s6, s82, 1
    s_and_b32 s6, s6, 3
    s_lshl_b32 s6, s6, 1
    s_add_u32 s6, s6, 1
    s_lshl_b32 s6, s6, 18
    buffer_load_dword v237, v3, s[56:59], s6 offen
L_wt_29:
    v_max3_f32 v234, v234, v138, v139
    s_waitcnt lgkmcnt(2)
    v_mfma_f32_16x16x32_bf16 v[72:75], v[216:219], v[224:227], v[72:75]
    v_add_f32 v233, v233, v126
    v_max3_f32 v235, v235, v140, v141
    v_mfma_f32_16x16x32_bf16 v[104:107], v[216:219], v[228:231], v[104:107]
    v_add_f32 v232, v232, v119
    v_max3_f32 v234, v234, v142, v143
    s_waitcnt lgkmcnt(0)
    v_mfma_f32_16x16x32_bf16 v[108:111], v[220:223], v[228:231], v[108:111]
    v_add_f32 v233, v233, v127
    v_max_f32 v234, v234, v235
    v_mfma_f32_16x16x32_bf16 v[76:79], v[220:223], v[224:227], v[76:79]
    v_cmp_lt_f32 vcc, s100, v234
    s_mov_b32 s97, s96
    s_mov_b32 s96, s98
    s_mov_b32 s31, s30
    s_cbranch_vccnz L_stub_30
L_back_31:
    s_waitcnt vmcnt(8)
    s_barrier
    s_add_u32 s98, s96, 34304
    s_cmp_eq_u32 s96, 128512
    s_cselect_b32 s98, 0, s98
    s_cmp_eq_u32 s96, 34304
    s_cselect_b32 s98, 94208, s98
    v_add_u32 v11, s98, v10
    v_add_u32 v13, s96, v12
    s_add_u32 s30, s31, 8192
    s_and_b32 s30, s30, 0x1ffff
    ds_read_b64_tr_b16 v[192:193], v13 offset:0
    ds_read_b64_tr_b16 v[194:195], v13 offset:512
    ds_read_b64_tr_b16 v[196:197], v13 offset:32
    ds_read_b64_tr_b16 v[198:199], v13 offset:544
    ds_read_b64_tr_b16 v[200:201], v13 offset:64
    ds_read_b64_tr_b16 v[202:203], v13 offset:576
    ds_read_b64_tr_b16 v[204:205], v13 offset:96
    ds_read_b64_tr_b16 v[206:207], v13 offset:608
    v_exp_f32 v128, v128
    v_exp_f32 v129, v129
    v_exp_f32 v130, v130
    v_exp_f32 v131, v131
    v_exp_f32 v132, v132
    v_exp_f32 v133, v133
    v_exp_f32 v134, v134
    v_exp_f32 v135, v135
    v_cvt_pk_bf16_f32 v224, v128, v129
    v_cvt_pk_bf16_f32 v225, v130, v131
    v_cvt_pk_bf16_f32 v226, v132, v133
    v_cvt_pk_bf16_f32 v227, v134, v135
    ds_read_b64_tr_b16 v[208:209], v13 offset:128
    ds_read_b64_tr_b16 v[210:211], v13 offset:640
    ds_read_b64_tr_b16 v[212:213], v13 offset:160
    ds_read_b64_tr_b16 v[214:215], v13 offset:672
    ds_read_b64_tr_b16 v[216:217], v13 offset:192
    ds_read_b64_tr_b16 v[218:219], v13 offset:704
    ds_read_b64_tr_b16 v[220:221], v13 offset:224
    ds_read_b64_tr_b16 v[222:223], v13 offset:736
    v_exp_f32 v136, v136
    v_exp_f32 v137, v137
    v_exp_f32 v138, v138
    v_exp_f32 v139, v139
    v_exp_f32 v140, v140
    v_exp_f32 v141, v141
    v_exp_f32 v142, v142
    v_exp_f32 v143, v143
    v_cvt_pk_bf16_f32 v228, v136, v137
    v_cvt_pk_bf16_f32 v229, v138, v139
    v_cvt_pk_bf16_f32 v230, v140, v141
    v_cvt_pk_bf16_f32 v231, v142, v143
    s_nop 0
    s_waitcnt lgkmcnt(14)
    v_mfma_f32_16x16x32_bf16 v[48:51], v[192:195], v[224:227], v[48:51]
    v_add_f32 v232, v232, v128
    s_cmp_lg_u32 s3, 6
    s_cbranch_scc1 L_wt_32
    s_add_u32 s6, s82, 2
    s_and_b32 s6, s6, 3
    s_lshl_b32 s6, s6, 1
    s_add_u32 s6, s6, 1
    s_lshl_b32 s6, s6, 18
    buffer_load_dword v237, v3, s[56:59], s6 offen
L_wt_32:
    s_cmp_lg_u32 s3, 7
    s_cbranch_scc1 L_wt_33
    s_add_u32 s6, s82, 3
    s_and_b32 s6, s6, 3
    s_lshl_b32 s6, s6, 1
    s_add_u32 s6, s6, 1
    s_lshl_b32 s6, s6, 18
    buffer_load_dword v237, v3, s[56:59], s6 offen
L_wt_33:
    v_mfma_f32_16x16x32_bf16 v[80:83], v[192:195], v[228:231], v[80:83]
    v_add_f32 v233, v233, v136
    s_waitcnt lgkmcnt(12)
    v_mfma_f32_16x16x32_bf16 v[84:87], v[196:199], v[228:231], v[84:87]
    v_add_f32 v232, v232, v129
    v_mfma_f32_16x16x32_bf16 v[52:55], v[196:199], v[224:227], v[52:55]
    v_add_f32 v233, v233, v137
    s_waitcnt lgkmcnt(10)
    v_mfma_f32_16x16x32_bf16 v[56:59], v[200:203], v[224:227], v[56:59]
    v_add_f32 v232, v232, v130
    v_mfma_f32_16x16x32_bf16 v[88:91], v[200:203], v[228:231], v[88:91]
    v_add_f32 v233, v233, v138
    s_waitcnt lgkmcnt(8)
    v_mfma_f32_16x16x32_bf16 v[92:95], v[204:207], v[228:231], v[92:95]
    v_add_f32 v232, v232, v131
    v_mfma_f32_16x16x32_bf16 v[60:63], v[204:207], v[224:227], v[60:63]
    v_add_f32 v233, v233, v139
    s_waitcnt lgkmcnt(6)
    v_mfma_f32_16x16x32_bf16 v[64:67], v[208:211], v[224:227], v[64:67]
    v_add_f32 v232, v232, v132
    v_mfma_f32_16x16x32_bf16 v[96:99], v[208:211], v[228:231], v[96:99]
    v_add_f32 v233, v233, v140
    s_waitcnt lgkmcnt(4)
    v_mfma_f32_16x16x32_bf16 v[100:103], v[212:215], v[228:231], v[100:103]
    v_add_f32 v232, v232, v133
    v_mfma_f32_16x16x32_bf16 v[68:71], v[212:215], v[224:227], v[68:71]
    v_add_f32 v233, v233, v141
    s_waitcnt lgkmcnt(2)
    v_mfma_f32_16x16x32_bf16 v[72:75], v[216:219], v[224:227], v[72:75]
    v_add_f32 v232, v232, v134
    v_mfma_f32_16x16x32_bf16 v[104:107], v[216:219], v[228:231], v[104:107]
    v_add_f32 v233, v233, v142
    s_waitcnt lgkmcnt(0)
    v_mfma_f32_16x16x32_bf16 v[108:111], v[220:223], v[228:231], v[108:111]
    v_add_f32 v232, v232, v135
    v_mfma_f32_16x16x32_bf16 v[76:79], v[220:223], v[224:227], v[76:79]
    v_add_f32 v233, v233, v143
    s_nop 0
    v_mov_b32 v235, v232
    s_nop 1
    v_permlane16_swap_b32 v235, v232
    s_nop 1
    v_add_f32 v232, v232, v235
    s_nop 0
    v_mov_b32 v235, v232
    s_nop 1
    v_permlane32_swap_b32 v235, v232
    s_nop 1
    v_add_f32 v232, v232, v235
    v_rcp_f32 v232, v232
    s_nop 0
    v_mov_b32 v235, v233
    s_nop 1
    v_permlane16_swap_b32 v235, v233
    s_nop 1
    v_add_f32 v233, v233, v235
    s_nop 0
    v_mov_b32 v235, v233
    s_nop 1
    v_permlane32_swap_b32 v235, v233
    s_nop 1
    v_add_f32 v233, v233, v235
    v_rcp_f32 v233, v233
    s_mul_i32 s34, s82, 57344
    s_barrier
    s_cmp_ge_u32 s3, 4
    s_cbranch_scc1 L_epx2
    v_pk_mul_f32 v[48:49], v[48:49], v[232:233] op_sel:[0,0] op_sel_hi:[1,0]
    v_pk_mul_f32 v[50:51], v[50:51], v[232:233] op_sel:[0,0] op_sel_hi:[1,0]
    v_pk_mul_f32 v[52:53], v[52:53], v[232:233] op_sel:[0,0] op_sel_hi:[1,0]
    v_pk_mul_f32 v[54:55], v[54:55], v[232:233] op_sel:[0,0] op_sel_hi:[1,0]
    v_cvt_pk_bf16_f32 v48, v48, v49
    v_cvt_pk_bf16_f32 v49, v50, v51
    v_cvt_pk_bf16_f32 v50, v52, v53
    v_cvt_pk_bf16_f32 v51, v54, v55
    ds_write_b128 v14, v[48:51] offset:0
    buffer_store_dwordx4 v[48:51], v14, s[52:55], s34 offen offset:0 sc1
    v_pk_mul_f32 v[80:81], v[80:81], v[232:233] op_sel:[0,1] op_sel_hi:[1,1]
    v_pk_mul_f32 v[82:83], v[82:83], v[232:233] op_sel:[0,1] op_sel_hi:[1,1]
    v_pk_mul_f32 v[84:85], v[84:85], v[232:233] op_sel:[0,1] op_sel_hi:[1,1]
    v_pk_mul_f32 v[86:87], v[86:87], v[232:233] op_sel:[0,1] op_sel_hi:[1,1]
    v_cvt_pk_bf16_f32 v80, v80, v81
    v_cvt_pk_bf16_f32 v81, v82, v83
    v_cvt_pk_bf16_f32 v82, v84, v85
    v_cvt_pk_bf16_f32 v83, v86, v87
    ds_write_b128 v14, v[80:83] offset:1024
    buffer_store_dwordx4 v[80:83], v14, s[52:55], s34 offen offset:1024 sc1
    s_add_u32 s34, s34, 7168
    v_pk_mul_f32 v[56:57], v[56:57], v[232:233] op_sel:[0,0] op_sel_hi:[1,0]
    v_pk_mul_f32 v[58:59], v[58:59], v[232:233] op_sel:[0,0] op_sel_hi:[1,0]
    v_pk_mul_f32 v[60:61], v[60:61], v[232:233] op_sel:[0,0] op_sel_hi:[1,0]
    v_pk_mul_f32 v[62:63], v[62:63], v[232:233] op_sel:[0,0] op_sel_hi:[1,0]
    v_cvt_pk_bf16_f32 v56, v56, v57
    v_cvt_pk_bf16_f32 v57, v58, v59
    v_cvt_pk_bf16_f32 v58, v60, v61
    v_cvt_pk_bf16_f32 v59, v62, v63
    ds_write_b128 v14, v[56:59] offset:7168
    buffer_store_dwordx4 v[56:59], v14, s[52:55], s34 offen offset:0 sc1
    v_pk_mul_f32 v[88:89], v[88:89], v[232:233] op_sel:[0,1] op_sel_hi:[1,1]
    v_pk_mul_f32 v[90:91], v[90:91], v[232:233] op_sel:[0,1] op_sel_hi:[1,1]
    v_pk_mul_f32 v[92:93], v[92:93], v[232:233] op_sel:[0,1] op_sel_hi:[1,1]
    v_pk_mul_f32 v[94:95], v[94:95], v[232:233] op_sel:[0,1] op_sel_hi:[1,1]
    v_cvt_pk_bf16_f32 v88, v88, v89
    v_cvt_pk_bf16_f32 v89, v90, v91
    v_cvt_pk_bf16_f32 v90, v92, v93
    v_cvt_pk_bf16_f32 v91, v94, v95
    ds_write_b128 v14, v[88:91] offset:8192
    buffer_store_dwordx4 v[88:91], v14, s[52:55], s34 offen offset:1024 sc1
    s_add_u32 s34, s34, 7168
    v_pk_mul_f32 v[64:65], v[64:65], v[232:233] op_sel:[0,0] op_sel_hi:[1,0]
    v_pk_mul_f32 v[66:67], v[66:67], v[232:233] op_sel:[0,0] op_sel_hi:[1,0]
    v_pk_mul_f32 v[68:69], v[68:69], v[232:233] op_sel:[0,0] op_sel_hi:[1,0]
    v_pk_mul_f32 v[70:71], v[70:71], v[232:233] op_sel:[0,0] op_sel_hi:[1,0]
    v_cvt_pk_bf16_f32 v64, v64, v65
    v_cvt_pk_bf16_f32 v65, v66, v67
    v_cvt_pk_bf16_f32 v66, v68, v69
    v_cvt_pk_bf16_f32 v67, v70, v71
    ds_write_b128 v14, v[64:67] offset:14336
    buffer_store_dwordx4 v[64:67], v14, s[52:55], s34 offen offset:0 sc1
    v_pk_mul_f32 v[96:97], v[96:97], v[232:233] op_sel:[0,1] op_sel_hi:[1,1]
    v_pk_mul_f32 v[98:99], v[98:99], v[232:233] op_sel:[0,1] op_sel_hi:[1,1]
    v_pk_mul_f32 v[100:101], v[100:101], v[232:233] op_sel:[0,1] op_sel_hi:[1,1]
    v_pk_mul_f32 v[102:103], v[102:103], v[232:233] op_sel:[0,1] op_sel_hi:[1,1]
    v_cvt_pk_bf16_f32 v96, v96, v97
    v_cvt_pk_bf16_f32 v97, v98, v99
    v_cvt_pk_bf16_f32 v98, v100, v101
    v_cvt_pk_bf16_f32 v99, v102, v103
    ds_write_b128 v14, v[96:99] offset:15360
    buffer_store_dwordx4 v[96:99], v14, s[52:55], s34 offen offset:1024 sc1
    s_add_u32 s34, s34, 7168
    v_pk_mul_f32 v[72:73], v[72:73], v[232:233] op_sel:[0,0] op_sel_hi:[1,0]
    v_pk_mul_f32 v[74:75], v[74:75], v[232:233] op_sel:[0,0] op_sel_hi:[1,0]
    v_pk_mul_f32 v[76:77], v[76:77], v[232:233] op_sel:[0,0] op_sel_hi:[1,0]
    v_pk_mul_f32 v[78:79], v[78:79], v[232:233] op_sel:[0,0] op_sel_hi:[1,0]
    v_cvt_pk_bf16_f32 v72, v72, v73
    v_cvt_pk_bf16_f32 v73, v74, v75
    v_cvt_pk_bf16_f32 v74, v76, v77
    v_cvt_pk_bf16_f32 v75, v78, v79
    ds_write_b128 v14, v[72:75] offset:21504
    buffer_store_dwordx4 v[72:75], v14, s[52:55], s34 offen offset:0 sc1
    v_pk_mul_f32 v[104:105], v[104:105], v[232:233] op_sel:[0,1] op_sel_hi:[1,1]
    v_pk_mul_f32 v[106:107], v[106:107], v[232:233] op_sel:[0,1] op_sel_hi:[1,1]
    v_pk_mul_f32 v[108:109], v[108:109], v[232:233] op_sel:[0,1] op_sel_hi:[1,1]
    v_pk_mul_f32 v[110:111], v[110:111], v[232:233] op_sel:[0,1] op_sel_hi:[1,1]
    v_cvt_pk_bf16_f32 v104, v104, v105
    v_cvt_pk_bf16_f32 v105, v106, v107
    v_cvt_pk_bf16_f32 v106, v108, v109
    v_cvt_pk_bf16_f32 v107, v110, v111
    ds_write_b128 v14, v[104:107] offset:22528
    buffer_store_dwordx4 v[104:107], v14, s[52:55], s34 offen offset:1024 sc1
    s_add_u32 s34, s34, 7168
    s_waitcnt vmcnt(8)
    s_branch L_oload
L_epx2:
    v_pk_mul_f32 v[48:49], v[48:49], v[232:233] op_sel:[0,0] op_sel_hi:[1,0]
    v_pk_mul_f32 v[50:51], v[50:51], v[232:233] op_sel:[0,0] op_sel_hi:[1,0]
    v_pk_mul_f32 v[52:53], v[52:53], v[232:233] op_sel:[0,0] op_sel_hi:[1,0]
    v_pk_mul_f32 v[54:55], v[54:55], v[232:233] op_sel:[0,0] op_sel_hi:[1,0]
    v_cvt_pk_bf16_f32 v48, v48, v49
    v_cvt_pk_bf16_f32 v49, v50, v51
    v_cvt_pk_bf16_f32 v50, v52, v53
    v_cvt_pk_bf16_f32 v51, v54, v55
    ds_write_b128 v14, v[48:51] offset:0
    v_pk_mul_f32 v[80:81], v[80:81], v[232:233] op_sel:[0,1] op_sel_hi:[1,1]
    v_pk_mul_f32 v[82:83], v[82:83], v[232:233] op_sel:[0,1] op_sel_hi:[1,1]
    v_pk_mul_f32 v[84:85], v[84:85], v[232:233] op_sel:[0,1] op_sel_hi:[1,1]
    v_pk_mul_f32 v[86:87], v[86:87], v[232:233] op_sel:[0,1] op_sel_hi:[1,1]
    v_cvt_pk_bf16_f32 v80, v80, v81
    v_cvt_pk_bf16_f32 v81, v82, v83
    v_cvt_pk_bf16_f32 v82, v84, v85
    v_cvt_pk_bf16_f32 v83, v86, v87
    ds_write_b128 v14, v[80:83] offset:1024
    v_pk_mul_f32 v[56:57], v[56:57], v[232:233] op_sel:[0,0] op_sel_hi:[1,0]
    v_pk_mul_f32 v[58:59], v[58:59], v[232:233] op_sel:[0,0] op_sel_hi:[1,0]
    v_pk_mul_f32 v[60:61], v[60:61], v[232:233] op_sel:[0,0] op_sel_hi:[1,0]
    v_pk_mul_f32 v[62:63], v[62:63], v[232:233] op_sel:[0,0] op_sel_hi:[1,0]
    v_cvt_pk_bf16_f32 v56, v56, v57
    v_cvt_pk_bf16_f32 v57, v58, v59
    v_cvt_pk_bf16_f32 v58, v60, v61
    v_cvt_pk_bf16_f32 v59, v62, v63
    ds_write_b128 v14, v[56:59] offset:7168
    v_pk_mul_f32 v[88:89], v[88:89], v[232:233] op_sel:[0,1] op_sel_hi:[1,1]
    v_pk_mul_f32 v[90:91], v[90:91], v[232:233] op_sel:[0,1] op_sel_hi:[1,1]
    v_pk_mul_f32 v[92:93], v[92:93], v[232:233] op_sel:[0,1] op_sel_hi:[1,1]
    v_pk_mul_f32 v[94:95], v[94:95], v[232:233] op_sel:[0,1] op_sel_hi:[1,1]
    v_cvt_pk_bf16_f32 v88, v88, v89
    v_cvt_pk_bf16_f32 v89, v90, v91
    v_cvt_pk_bf16_f32 v90, v92, v93
    v_cvt_pk_bf16_f32 v91, v94, v95
    ds_write_b128 v14, v[88:91] offset:8192
    v_pk_mul_f32 v[64:65], v[64:65], v[232:233] op_sel:[0,0] op_sel_hi:[1,0]
    v_pk_mul_f32 v[66:67], v[66:67], v[232:233] op_sel:[0,0] op_sel_hi:[1,0]
    v_pk_mul_f32 v[68:69], v[68:69], v[232:233] op_sel:[0,0] op_sel_hi:[1,0]
    v_pk_mul_f32 v[70:71], v[70:71], v[232:233] op_sel:[0,0] op_sel_hi:[1,0]
    v_cvt_pk_bf16_f32 v64, v64, v65
    v_cvt_pk_bf16_f32 v65, v66, v67
    v_cvt_pk_bf16_f32 v66, v68, v69
    v_cvt_pk_bf16_f32 v67, v70, v71
    ds_write_b128 v14, v[64:67] offset:14336
    v_pk_mul_f32 v[96:97], v[96:97], v[232:233] op_sel:[0,1] op_sel_hi:[1,1]
    v_pk_mul_f32 v[98:99], v[98:99], v[232:233] op_sel:[0,1] op_sel_hi:[1,1]
    v_pk_mul_f32 v[100:101], v[100:101], v[232:233] op_sel:[0,1] op_sel_hi:[1,1]
    v_pk_mul_f32 v[102:103], v[102:103], v[232:233] op_sel:[0,1] op_sel_hi:[1,1]
    v_cvt_pk_bf16_f32 v96, v96, v97
    v_cvt_pk_bf16_f32 v97, v98, v99
    v_cvt_pk_bf16_f32 v98, v100, v101
    v_cvt_pk_bf16_f32 v99, v102, v103
    ds_write_b128 v14, v[96:99] offset:15360
    v_pk_mul_f32 v[72:73], v[72:73], v[232:233] op_sel:[0,0] op_sel_hi:[1,0]
    v_pk_mul_f32 v[74:75], v[74:75], v[232:233] op_sel:[0,0] op_sel_hi:[1,0]
    v_pk_mul_f32 v[76:77], v[76:77], v[232:233] op_sel:[0,0] op_sel_hi:[1,0]
    v_pk_mul_f32 v[78:79], v[78:79], v[232:233] op_sel:[0,0] op_sel_hi:[1,0]
    v_cvt_pk_bf16_f32 v72, v72, v73
    v_cvt_pk_bf16_f32 v73, v74, v75
    v_cvt_pk_bf16_f32 v74, v76, v77
    v_cvt_pk_bf16_f32 v75, v78, v79
    ds_write_b128 v14, v[72:75] offset:21504
    v_pk_mul_f32 v[104:105], v[104:105], v[232:233] op_sel:[0,1] op_sel_hi:[1,1]
    v_pk_mul_f32 v[106:107], v[106:107], v[232:233] op_sel:[0,1] op_sel_hi:[1,1]
    v_pk_mul_f32 v[108:109], v[108:109], v[232:233] op_sel:[0,1] op_sel_hi:[1,1]
    v_pk_mul_f32 v[110:111], v[110:111], v[232:233] op_sel:[0,1] op_sel_hi:[1,1]
    v_cvt_pk_bf16_f32 v104, v104, v105
    v_cvt_pk_bf16_f32 v105, v106, v107
    v_cvt_pk_bf16_f32 v106, v108, v109
    v_cvt_pk_bf16_f32 v107, v110, v111
    ds_write_b128 v14, v[104:107] offset:22528
    s_branch L_omm
L_attn1:
    s_barrier
    ds_read_b128 v[16:19], v9 offset:0
    ds_read_b128 v[20:23], v9 offset:1024
    ds_read_b128 v[24:27], v9 offset:2048
    ds_read_b128 v[28:31], v9 offset:3072
    ds_read_b128 v[160:163], v11 offset:0
    ds_read_b128 v[176:179], v11 offset:512
    ds_read_b128 v[164:167], v11 offset:64
    ds_read_b128 v[180:183], v11 offset:576
    ds_read_b128 v[168:171], v11 offset:128
    ds_read_b128 v[184:187], v11 offset:640
    ds_read_b128 v[172:175], v11 offset:192
    ds_read_b128 v[188:191], v11 offset:704
    s_waitcnt lgkmcnt(8)
    s_barrier
    s_waitcnt lgkmcnt(7)
    v_mfma_f32_16x16x32_bf16 v[112:115], v[160:163], v[16:19], 0
    s_add_u32 s34, s97, s86
    s_add_u32 m0, s34, 0
    s_add_u32 s35, s31, 0
    buffer_load_dwordx4 v2, s[44:47], s35 offen nt lds
    s_waitcnt lgkmcnt(6)
    v_mfma_f32_16x16x32_bf16 v[116:119], v[176:179], v[16:19], 0
    s_waitcnt lgkmcnt(5)
    v_mfma_f32_16x16x32_bf16 v[112:115], v[164:167], v[20:23], v[112:115]
    s_add_u32 s34, s97, s86
    s_add_u32 m0, s34, 4224
    s_add_u32 s35, s31, 1024
    buffer_load_dwordx4 v2, s[44:47], s35 offen nt lds
    s_waitcnt lgkmcnt(4)
    v_mfma_f32_16x16x32_bf16 v[116:119], v[180:183], v[20:23], v[116:119]
    s_waitcnt lgkmcnt(3)
    v_mfma_f32_16x16x32_bf16 v[112:115], v[168:171], v[24:27], v[112:115]
    s_waitcnt lgkmcnt(2)
    v_mfma_f32_16x16x32_bf16 v[116:119], v[184:187], v[24:27], v[116:119]
    s_waitcnt lgkmcnt(1)
    v_mfma_f32_16x16x32_bf16 v[112:115], v[172:175], v[28:31], v[112:115]
    s_waitcnt lgkmcnt(0)
    v_mfma_f32_16x16x32_bf16 v[116:119], v[188:191], v[28:31], v[116:119]
    s_nop 7
    v_max3_f32 v234, v112, v113, v114
    v_max3_f32 v235, v115, v116, v117
    v_max3_f32 v234, v234, v118, v119
    v_max_f32 v234, v234, v235
    s_nop 0
    v_mov_b32 v235, v234
    s_nop 1
    v_permlane16_swap_b32 v235, v234
    s_nop 1
    v_max_f32 v234, v234, v235
    s_nop 0
    v_mov_b32 v235, v234
    s_nop 1
    v_permlane32_swap_b32 v235, v234
    s_nop 1
    v_max_f32 v234, v234, v235
    v_mov_b32 v232, 0
    v_sub_f32 v112, v112, v234
    v_sub_f32 v113, v113, v234
    v_sub_f32 v114, v114, v234
    v_sub_f32 v115, v115, v234
    v_sub_f32 v116, v116, v234
    v_sub_f32 v117, v117, v234
    v_sub_f32 v118, v118, v234
    v_sub_f32 v119, v119, v234
    v_sub_f32 v144, 0, v234
    v_sub_f32 v145, 0, v234
    v_sub_f32 v146, 0, v234
    v_sub_f32 v147, 0, v234
    s_waitcnt vmcnt(14)
    s_barrier
    s_add_u32 s98, s96, 34304
    s_cmp_eq_u32 s96, 128512
    s_cselect_b32 s98, 0, s98
    s_cmp_eq_u32 s96, 34304
    s_cselect_b32 s98, 94208, s98
    v_add_u32 v11, s98, v10
    v_add_u32 v13, s96, v12
    s_add_u32 s30, s31, 8192
    s_and_b32 s30, s30, 0x1ffff
    ds_read_b128 v[160:163], v11 offset:0
    ds_read_b128 v[176:179], v11 offset:512
    ds_read_b128 v[164:167], v11 offset:64
    ds_read_b128 v[180:183], v11 offset:576
    ds_read_b128 v[168:171], v11 offset:128
    ds_read_b128 v[184:187], v11 offset:640
    ds_read_b128 v[172:175], v11 offset:192
    ds_read_b128 v[188:191], v11 offset:704
    v_exp_f32 v112, v112
    v_exp_f32 v113, v113
    v_exp_f32 v114, v114
    v_exp_f32 v115, v115
    v_exp_f32 v116, v116
    v_exp_f32 v117, v117
    v_exp_f32 v118, v118
    v_exp_f32 v119, v119
    s_waitcnt lgkmcnt(7)
    v_mfma_f32_16x16x32_bf16 v[128:131], v[160:163], v[16:19], v[144:147]
    ds_read_b64_tr_b16 v[192:193], v13 offset:0
    ds_read_b64_tr_b16 v[194:195], v13 offset:512
    v_cvt_pk_bf16_f32 v224, v112, v113
    s_waitcnt lgkmcnt(8)
    v_mfma_f32_16x16x32_bf16 v[132:135], v[176:179], v[16:19], v[144:147]
    ds_read_b64_tr_b16 v[196:197], v13 offset:32
    ds_read_b64_tr_b16 v[198:199], v13 offset:544
    v_cvt_pk_bf16_f32 v225, v114, v115
    s_waitcnt lgkmcnt(9)
    v_mfma_f32_16x16x32_bf16 v[128:131], v[164:167], v[20:23], v[128:131]
    ds_read_b64_tr_b16 v[200:201], v13 offset:64
    ds_read_b64_tr_b16 v[202:203], v13 offset:576
    v_cvt_pk_bf16_f32 v226, v116, v117
    s_waitcnt lgkmcnt(10)
    v_mfma_f32_16x16x32_bf16 v[132:135], v[180:183], v[20:23], v[132:135]
    ds_read_b64_tr_b16 v[204:205], v13 offset:96
    ds_read_b64_tr_b16 v[206:207], v13 offset:608
    v_cvt_pk_bf16_f32 v227, v118, v119
    s_waitcnt lgkmcnt(11)
    v_mfma_f32_16x16x32_bf16 v[128:131], v[168:171], v[24:27], v[128:131]
    ds_read_b64_tr_b16 v[208:209], v13 offset:128
    ds_read_b64_tr_b16 v[210:211], v13 offset:640
    v_add_f32 v232, v232, v112
    s_waitcnt lgkmcnt(12)
    v_mfma_f32_16x16x32_bf16 v[132:135], v[184:187], v[24:27], v[132:135]
    ds_read_b64_tr_b16 v[212:213], v13 offset:160
    ds_read_b64_tr_b16 v[214:215], v13 offset:672
    v_add_f32 v232, v232, v113
    s_waitcnt lgkmcnt(13)
    v_mfma_f32_16x16x32_bf16 v[128:131], v[172:175], v[28:31], v[128:131]
    ds_read_b64_tr_b16 v[216:217], v13 offset:192
    ds_read_b64_tr_b16 v[218:219], v13 offset:704
    v_add_f32 v232, v232, v114
    s_waitcnt lgkmcnt(14)
    v_mfma_f32_16x16x32_bf16 v[132:135], v[188:191], v[28:31], v[132:135]
    ds_read_b64_tr_b16 v[220:221], v13 offset:224
    ds_read_b64_tr_b16 v[222:223], v13 offset:736
    v_add_f32 v232, v232, v115
    s_nop 0
    s_waitcnt lgkmcnt(14)
    v_mfma_f32_16x16x32_bf16 v[48:51], v[192:195], v[224:227], 0
    v_add_f32 v232, v232, v116
    s_add_u32 s34, s96, s86
    s_add_u32 m0, s34, 0
    s_add_u32 s35, s30, 0
    buffer_load_dwordx4 v2, s[44:47], s35 offen nt lds
    s_waitcnt lgkmcnt(12)
    v_mfma_f32_16x16x32_bf16 v[52:55], v[196:199], v[224:227], 0
    v_add_f32 v232, v232, v117
    s_add_u32 s34, s97, s87
    s_add_u32 m0, s34, 0
    s_add_u32 s35, s31, 0
    buffer_load_dwordx4 v2, s[48:51], s35 offen nt lds
    s_waitcnt lgkmcnt(10)
    v_mfma_f32_16x16x32_bf16 v[56:59], v[200:203], v[224:227], 0
    s_waitcnt lgkmcnt(8)
    v_mfma_f32_16x16x32_bf16 v[60:63], v[204:207], v[224:227], 0
    v_add_f32 v232, v232, v118
    s_add_u32 s34, s96, s86
    s_add_u32 m0, s34, 4224
    s_add_u32 s35, s30, 1024
    buffer_load_dwordx4 v2, s[44:47], s35 offen nt lds
    v_max3_f32 v234, v128, v129, v130
    s_waitcnt lgkmcnt(6)
    v_mfma_f32_16x16x32_bf16 v[64:67], v[208:211], v[224:227], 0
    v_max3_f32 v235, v131, v132, v133
    s_waitcnt lgkmcnt(4)
    v_mfma_f32_16x16x32_bf16 v[68:71], v[212:215], v[224:227], 0
    v_add_f32 v232, v232, v119
    s_add_u32 s34, s97, s87
    s_add_u32 m0, s34, 4224
    s_add_u32 s35, s31, 1024
    buffer_load_dwordx4 v2, s[48:51], s35 offen nt lds
    v_max3_f32 v234, v234, v134, v135
    s_waitcnt lgkmcnt(2)
    v_mfma_f32_16x16x32_bf16 v[72:75], v[216:219], v[224:227], 0
    v_max_f32 v234, v234, v235
    s_waitcnt lgkmcnt(0)
    v_mfma_f32_16x16x32_bf16 v[76:79], v[220:223], v[224:227], 0
    v_cmp_lt_f32 vcc, s100, v234
    s_mov_b32 s97, s96
    s_mov_b32 s96, s98
    s_mov_b32 s31, s30
    s_cbranch_vccnz L_stub_34
L_back_35:
    s_waitcnt vmcnt(10)
    s_barrier
    s_add_u32 s98, s96, 34304
    s_cmp_eq_u32 s96, 128512
    s_cselect_b32 s98, 0, s98
    s_cmp_eq_u32 s96, 34304
    s_cselect_b32 s98, 94208, s98
    v_add_u32 v11, s98, v10
    v_add_u32 v13, s96, v12
    s_add_u32 s30, s31, 8192
    s_and_b32 s30, s30, 0x1ffff
    ds_read_b128 v[160:163], v11 offset:0
    ds_read_b128 v[176:179], v11 offset:512
    ds_read_b128 v[164:167], v11 offset:64
    ds_read_b128 v[180:183], v11 offset:576
    ds_read_b128 v[168:171], v11 offset:128
    ds_read_b128 v[184:187], v11 offset:640
    ds_read_b128 v[172:175], v11 offset:192
    ds_read_b128 v[188:191], v11 offset:704
    v_exp_f32 v128, v128
    v_exp_f32 v129, v129
    v_exp_f32 v130, v130
    v_exp_f32 v131, v131
    v_exp_f32 v132, v132
    v_exp_f32 v133, v133
    v_exp_f32 v134, v134
    v_exp_f32 v135, v135
    s_waitcnt lgkmcnt(7)
    v_mfma_f32_16x16x32_bf16 v[112:115], v[160:163], v[16:19], v[144:147]
    ds_read_b64_tr_b16 v[192:193], v13 offset:0
    ds_read_b64_tr_b16 v[194:195], v13 offset:512
    v_cvt_pk_bf16_f32 v224, v128, v129
    s_waitcnt lgkmcnt(8)
    v_mfma_f32_16x16x32_bf16 v[116:119], v[176:179], v[16:19], v[144:147]
    ds_read_b64_tr_b16 v[196:197], v13 offset:32
    ds_read_b64_tr_b16 v[198:199], v13 offset:544
    v_cvt_pk_bf16_f32 v225, v130, v131
    s_waitcnt lgkmcnt(9)
    v_mfma_f32_16x16x32_bf16 v[112:115], v[164:167], v[20:23], v[112:115]
    ds_read_b64_tr_b16 v[200:201], v13 offset:64
    ds_read_b64_tr_b16 v[202:203], v13 offset:576
    v_cvt_pk_bf16_f32 v226, v132, v133
    s_waitcnt lgkmcnt(10)
    v_mfma_f32_16x16x32_bf16 v[116:119], v[180:183], v[20:23], v[116:119]
    ds_read_b64_tr_b16 v[204:205], v13 offset:96
    ds_read_b64_tr_b16 v[206:207], v13 offset:608
    v_cvt_pk_bf16_f32 v227, v134, v135
    s_waitcnt lgkmcnt(11)
    v_mfma_f32_16x16x32_bf16 v[112:115], v[168:171], v[24:27], v[112:115]
    ds_read_b64_tr_b16 v[208:209], v13 offset:128
    ds_read_b64_tr_b16 v[210:211], v13 offset:640
    v_add_f32 v232, v232, v128
    s_waitcnt lgkmcnt(12)
    v_mfma_f32_16x16x32_bf16 v[116:119], v[184:187], v[24:27], v[116:119]
    ds_read_b64_tr_b16 v[212:213], v13 offset:160
    ds_read_b64_tr_b16 v[214:215], v13 offset:672
    v_add_f32 v232, v232, v129
    s_waitcnt lgkmcnt(13)
    v_mfma_f32_16x16x32_bf16 v[112:115], v[172:175], v[28:31], v[112:115]
    ds_read_b64_tr_b16 v[216:217], v13 offset:192
    ds_read_b64_tr_b16 v[218:219], v13 offset:704
    v_add_f32 v232, v232, v130
    s_waitcnt lgkmcnt(14)
    v_mfma_f32_16x16x32_bf16 v[116:119], v[188:191], v[28:31], v[116:119]
    ds_read_b64_tr_b16 v[220:221], v13 offset:224
    ds_read_b64_tr_b16 v[222:223], v13 offset:736
    v_add_f32 v232, v232, v131
    s_nop 0
    s_waitcnt lgkmcnt(14)
    v_mfma_f32_16x16x32_bf16 v[48:51], v[192:195], v[224:227], v[48:51]
    v_add_f32 v232, v232, v132
    s_add_u32 s34, s96, s86
    s_add_u32 m0, s34, 0
    s_add_u32 s35, s30, 0
    buffer_load_dwordx4 v2, s[44:47], s35 offen nt lds
    s_waitcnt lgkmcnt(12)
    v_mfma_f32_16x16x32_bf16 v[52:55], v[196:199], v[224:227], v[52:55]
    v_add_f32 v232, v232, v133
    s_add_u32 s34, s97, s87
    s_add_u32 m0, s34, 0
    s_add_u32 s35, s31, 0
    buffer_load_dwordx4 v2, s[48:51], s35 offen nt lds
    s_waitcnt lgkmcnt(10)
    v_mfma_f32_16x16x32_bf16 v[56:59], v[200:203], v[224:227], v[56:59]
    s_waitcnt lgkmcnt(8)
    v_mfma_f32_16x16x32_bf16 v[60:63], v[204:207], v[224:227], v[60:63]
    v_add_f32 v232, v232, v134
    s_add_u32 s34, s96, s86
    s_add_u32 m0, s34, 4224
    s_add_u32 s35, s30, 1024
    buffer_load_dwordx4 v2, s[44:47], s35 offen nt lds
    v_max3_f32 v234, v112, v113, v114
    s_waitcnt lgkmcnt(6)
    v_mfma_f32_16x16x32_bf16 v[64:67], v[208:211], v[224:227], v[64:67]
    v_max3_f32 v235, v115, v116, v117
    s_waitcnt lgkmcnt(4)
    v_mfma_f32_16x16x32_bf16 v[68:71], v[212:215], v[224:227], v[68:71]
    v_add_f32 v232, v232, v135
    s_add_u32 s34, s97, s87
    s_add_u32 m0, s34, 4224
    s_add_u32 s35, s31, 1024
    buffer_load_dwordx4 v2, s[48:51], s35 offen nt lds
    v_max3_f32 v234, v234, v118, v119
    s_waitcnt lgkmcnt(2)
    v_mfma_f32_16x16x32_bf16 v[72:75], v[216:219], v[224:227], v[72:75]
    v_max_f32 v234, v234, v235
    s_waitcnt lgkmcnt(0)
    v_mfma_f32_16x16x32_bf16 v[76:79], v[220:223], v[224:227], v[76:79]
    v_cmp_lt_f32 vcc, s100, v234
    s_mov_b32 s97, s96
    s_mov_b32 s96, s98
    s_mov_b32 s31, s30
    s_cbranch_vccnz L_stub_36
L_back_37:
    s_mov_b32 s85, 0
L_aloop1:
    s_cmp_eq_u32 s94, 0
    s_cbranch_scc1 L_tw_38
    s_waitcnt vmcnt(4)
    s_cmp_eq_u32 s94, 1
    s_cbranch_scc1 L_tw_38
    s_waitcnt vmcnt(4)
L_tw_38:
    s_waitcnt vmcnt(8)
    s_barrier
    s_add_u32 s98, s96, 34304
    s_cmp_eq_u32 s96, 128512
    s_cselect_b32 s98, 0, s98
    s_cmp_eq_u32 s96, 34304
    s_cselect_b32 s98, 94208, s98
    v_add_u32 v11, s98, v10
    v_add_u32 v13, s96, v12
    s_add_u32 s30, s31, 8192
    s_and_b32 s30, s30, 0x1ffff
    ds_read_b128 v[160:163], v11 offset:0
    ds_read_b128 v[176:179], v11 offset:512
    ds_read_b128 v[164:167], v11 offset:64
    ds_read_b128 v[180:183], v11 offset:576
    ds_read_b128 v[168:171], v11 offset:128
    ds_read_b128 v[184:187], v11 offset:640
    ds_read_b128 v[172:175], v11 offset:192
    ds_read_b128 v[188:191], v11 offset:704
    v_exp_f32 v112, v112
    v_exp_f32 v113, v113
    v_exp_f32 v114, v114
    v_exp_f32 v115, v115
    v_exp_f32 v116, v116
    v_exp_f32 v117, v117
    v_exp_f32 v118, v118
    v_exp_f32 v119, v119
    s_waitcnt lgkmcnt(7)
    v_mfma_f32_16x16x32_bf16 v[128:131], v[160:163], v[16:19], v[144:147]
    ds_read_b64_tr_b16 v[192:193], v13 offset:0
    ds_read_b64_tr_b16 v[194:195], v13 offset:512
    v_cvt_pk_bf16_f32 v224, v112, v113
    s_waitcnt lgkmcnt(8)
    v_mfma_f32_16x16x32_bf16 v[132:135], v[176:179], v[16:19], v[144:147]
    ds_read_b64_tr_b16 v[196:197], v13 offset:32
    ds_read_b64_tr_b16 v[198:199], v13 offset:544
    v_cvt_pk_bf16_f32 v225, v114, v115
    s_waitcnt lgkmcnt(9)
    v_mfma_f32_16x16x32_bf16 v[128:131], v[164:167], v[20:23], v[128:131]
    ds_read_b64_tr_b16 v[200:201], v13 offset:64
    ds_read_b64_tr_b16 v[202:203], v13 offset:576
    v_cvt_pk_bf16_f32 v226, v116, v117
    s_waitcnt lgkmcnt(10)
    v_mfma_f32_16x16x32_bf16 v[132:135], v[180:183], v[20:23], v[132:135]
    ds_read_b64_tr_b16 v[204:205], v13 offset:96
    ds_read_b64_tr_b16 v[206:207], v13 offset:608
    v_cvt_pk_bf16_f32 v227, v118, v119
    s_waitcnt lgkmcnt(11)
    v_mfma_f32_16x16x32_bf16 v[128:131], v[168:171], v[24:27], v[128:131]
    ds_read_b64_tr_b16 v[208:209], v13 offset:128
    ds_read_b64_tr_b16 v[210:211], v13 offset:640
    v_add_f32 v232, v232, v112
    s_waitcnt lgkmcnt(12)
    v_mfma_f32_16x16x32_bf16 v[132:135], v[184:187], v[24:27], v[132:135]
    ds_read_b64_tr_b16 v[212:213], v13 offset:160
    ds_read_b64_tr_b16 v[214:215], v13 offset:672
    v_add_f32 v232, v232, v113
    s_waitcnt lgkmcnt(13)
    v_mfma_f32_16x16x32_bf16 v[128:131], v[172:175], v[28:31], v[128:131]
    ds_read_b64_tr_b16 v[216:217], v13 offset:192
    ds_read_b64_tr_b16 v[218:219], v13 offset:704
    v_add_f32 v232, v232, v114
    s_waitcnt lgkmcnt(14)
    v_mfma_f32_16x16x32_bf16 v[132:135], v[188:191], v[28:31], v[132:135]
    ds_read_b64_tr_b16 v[220:221], v13 offset:224
    ds_read_b64_tr_b16 v[222:223], v13 offset:736
    v_add_f32 v232, v232, v115
    s_nop 0
    s_waitcnt lgkmcnt(14)
    v_mfma_f32_16x16x32_bf16 v[48:51], v[192:195], v[224:227], v[48:51]
    v_add_f32 v232, v232, v116
    s_add_u32 s34, s96, s86
    s_add_u32 m0, s34, 0
    s_add_u32 s35, s30, 0
    buffer_load_dwordx4 v2, s[44:47], s35 offen nt lds
    s_waitcnt lgkmcnt(12)
    v_mfma_f32_16x16x32_bf16 v[52:55], v[196:199], v[224:227], v[52:55]
    v_add_f32 v232, v232, v117
    s_add_u32 s34, s97, s87
    s_add_u32 m0, s34, 0
    s_add_u32 s35, s31, 0
    buffer_load_dwordx4 v2, s[48:51], s35 offen nt lds
    s_waitcnt lgkmcnt(10)
    v_mfma_f32_16x16x32_bf16 v[56:59], v[200:203], v[224:227], v[56:59]
    s_waitcnt lgkmcnt(8)
    v_mfma_f32_16x16x32_bf16 v[60:63], v[204:207], v[224:227], v[60:63]
    v_add_f32 v232, v232, v118
    s_add_u32 s34, s96, s86
    s_add_u32 m0, s34, 4224
    s_add_u32 s35, s30, 1024
    buffer_load_dwordx4 v2, s[44:47], s35 offen nt lds
    v_max3_f32 v234, v128, v129, v130
    s_waitcnt lgkmcnt(6)
    v_mfma_f32_16x16x32_bf16 v[64:67], v[208:211], v[224:227], v[64:67]
    v_max3_f32 v235, v131, v132, v133
    s_waitcnt lgkmcnt(4)
    v_mfma_f32_16x16x32_bf16 v[68:71], v[212:215], v[224:227], v[68:71]
    v_add_f32 v232, v232, v119
    s_add_u32 s34, s97, s87
    s_add_u32 m0, s34, 4224
    s_add_u32 s35, s31, 1024
    buffer_load_dwordx4 v2, s[48:51], s35 offen nt lds
    v_max3_f32 v234, v234, v134, v135
    s_waitcnt lgkmcnt(2)
    v_mfma_f32_16x16x32_bf16 v[72:75], v[216:219], v[224:227], v[72:75]
    v_max_f32 v234, v234, v235
    s_waitcnt lgkmcnt(0)
    v_mfma_f32_16x16x32_bf16 v[76:79], v[220:223], v[224:227], v[76:79]
    v_cmp_lt_f32 vcc, s100, v234
    s_mov_b32 s97, s96
    s_mov_b32 s96, s98
    s_mov_b32 s31, s30
    s_cbranch_vccnz L_stub_39
L_back_40:
    s_cmp_eq_u32 s94, 0
    s_cbranch_scc1 L_tw_41
    s_waitcnt vmcnt(4)
    s_cmp_eq_u32 s94, 1
    s_cbranch_scc1 L_tw_41
    s_waitcnt vmcnt(4)
L_tw_41:
    s_waitcnt vmcnt(8)
    s_barrier
    s_add_u32 s98, s96, 34304
    s_cmp_eq_u32 s96, 128512
    s_cselect_b32 s98, 0, s98
    s_cmp_eq_u32 s96, 34304
    s_cselect_b32 s98, 94208, s98
    v_add_u32 v11, s98, v10
    v_add_u32 v13, s96, v12
    s_add_u32 s30, s31, 8192
    s_and_b32 s30, s30, 0x1ffff
    ds_read_b128 v[160:163], v11 offset:0
    ds_read_b128 v[176:179], v11 offset:512
    ds_read_b128 v[164:167], v11 offset:64
    ds_read_b128 v[180:183], v11 offset:576
    ds_read_b128 v[168:171], v11 offset:128
    ds_read_b128 v[184:187], v11 offset:640
    ds_read_b128 v[172:175], v11 offset:192
    ds_read_b128 v[188:191], v11 offset:704
    v_exp_f32 v128, v128
    v_exp_f32 v129, v129
    v_exp_f32 v130, v130
    v_exp_f32 v131, v131
    v_exp_f32 v132, v132
    v_exp_f32 v133, v133
    v_exp_f32 v134, v134
    v_exp_f32 v135, v135
    s_waitcnt lgkmcnt(7)
    v_mfma_f32_16x16x32_bf16 v[112:115], v[160:163], v[16:19], v[144:147]
    ds_read_b64_tr_b16 v[192:193], v13 offset:0
    ds_read_b64_tr_b16 v[194:195], v13 offset:512
    v_cvt_pk_bf16_f32 v224, v128, v129
    s_waitcnt lgkmcnt(8)
    v_mfma_f32_16x16x32_bf16 v[116:119], v[176:179], v[16:19], v[144:147]
    ds_read_b64_tr_b16 v[196:197], v13 offset:32
    ds_read_b64_tr_b16 v[198:199], v13 offset:544
    v_cvt_pk_bf16_f32 v225, v130, v131
    s_waitcnt lgkmcnt(9)
    v_mfma_f32_16x16x32_bf16 v[112:115], v[164:167], v[20:23], v[112:115]
    ds_read_b64_tr_b16 v[200:201], v13 offset:64
    ds_read_b64_tr_b16 v[202:203], v13 offset:576
    v_cvt_pk_bf16_f32 v226, v132, v133
    s_waitcnt lgkmcnt(10)
    v_mfma_f32_16x16x32_bf16 v[116:119], v[180:183], v[20:23], v[116:119]
    ds_read_b64_tr_b16 v[204:205], v13 offset:96
    ds_read_b64_tr_b16 v[206:207], v13 offset:608
    v_cvt_pk_bf16_f32 v227, v134, v135
    s_waitcnt lgkmcnt(11)
    v_mfma_f32_16x16x32_bf16 v[112:115], v[168:171], v[24:27], v[112:115]
    ds_read_b64_tr_b16 v[208:209], v13 offset:128
    ds_read_b64_tr_b16 v[210:211], v13 offset:640
    v_add_f32 v232, v232, v128
    s_waitcnt lgkmcnt(12)
    v_mfma_f32_16x16x32_bf16 v[116:119], v[184:187], v[24:27], v[116:119]
    ds_read_b64_tr_b16 v[212:213], v13 offset:160
    ds_read_b64_tr_b16 v[214:215], v13 offset:672
    v_add_f32 v232, v232, v129
    s_waitcnt lgkmcnt(13)
    v_mfma_f32_16x16x32_bf16 v[112:115], v[172:175], v[28:31], v[112:115]
    ds_read_b64_tr_b16 v[216:217], v13 offset:192
    ds_read_b64_tr_b16 v[218:219], v13 offset:704
    v_add_f32 v232, v232, v130
    s_waitcnt lgkmcnt(14)
    v_mfma_f32_16x16x32_bf16 v[116:119], v[188:191], v[28:31], v[116:119]
    ds_read_b64_tr_b16 v[220:221], v13 offset:224
    ds_read_b64_tr_b16 v[222:223], v13 offset:736
    v_add_f32 v232, v232, v131
    s_nop 0
    s_waitcnt lgkmcnt(14)
    v_mfma_f32_16x16x32_bf16 v[48:51], v[192:195], v[224:227], v[48:51]
    v_add_f32 v232, v232, v132
    s_add_u32 s34, s96, s86
    s_add_u32 m0, s34, 0
    s_add_u32 s35, s30, 0
    buffer_load_dwordx4 v2, s[44:47], s35 offen nt lds
    s_waitcnt lgkmcnt(12)
    v_mfma_f32_16x16x32_bf16 v[52:55], v[196:199], v[224:227], v[52:55]
    v_add_f32 v232, v232, v133
    s_add_u32 s34, s97, s87
    s_add_u32 m0, s34, 0
    s_add_u32 s35, s31, 0
    buffer_load_dwordx4 v2, s[48:51], s35 offen nt lds
    s_waitcnt lgkmcnt(10)
    v_mfma_f32_16x16x32_bf16 v[56:59], v[200:203], v[224:227], v[56:59]
    s_waitcnt lgkmcnt(8)
    v_mfma_f32_16x16x32_bf16 v[60:63], v[204:207], v[224:227], v[60:63]
    v_add_f32 v232, v232, v134
    s_add_u32 s34, s96, s86
    s_add_u32 m0, s34, 4224
    s_add_u32 s35, s30, 1024
    buffer_load_dwordx4 v2, s[44:47], s35 offen nt lds
    v_max3_f32 v234, v112, v113, v114
    s_waitcnt lgkmcnt(6)
    v_mfma_f32_16x16x32_bf16 v[64:67], v[208:211], v[224:227], v[64:67]
    v_max3_f32 v235, v115, v116, v117
    s_waitcnt lgkmcnt(4)
    v_mfma_f32_16x16x32_bf16 v[68:71], v[212:215], v[224:227], v[68:71]
    v_add_f32 v232, v232, v135
    s_add_u32 s34, s97, s87
    s_add_u32 m0, s34, 4224
    s_add_u32 s35, s31, 1024
    buffer_load_dwordx4 v2, s[48:51], s35 offen nt lds
    v_max3_f32 v234, v234, v118, v119
    s_waitcnt lgkmcnt(2)
    v_mfma_f32_16x16x32_bf16 v[72:75], v[216:219], v[224:227], v[72:75]
    v_max_f32 v234, v234, v235
    s_waitcnt lgkmcnt(0)
    v_mfma_f32_16x16x32_bf16 v[76:79], v[220:223], v[224:227], v[76:79]
    v_cmp_lt_f32 vcc, s100, v234
    s_mov_b32 s97, s96
    s_mov_b32 s96, s98
    s_mov_b32 s31, s30
    s_cbranch_vccnz L_stub_42
L_back_43:
    s_add_u32 s85, s85, 1
    s_cmp_lt_u32 s85, 5
    s_cbranch_scc1 L_aloop1
    s_waitcnt vmcnt(8)
    s_barrier
    s_add_u32 s98, s96, 34304
    s_cmp_eq_u32 s96, 128512
    s_cselect_b32 s98, 0, s98
    s_cmp_eq_u32 s96, 34304
    s_cselect_b32 s98, 94208, s98
    v_add_u32 v11, s98, v10
    v_add_u32 v13, s96, v12
    s_add_u32 s30, s31, 8192
    s_and_b32 s30, s30, 0x1ffff
    ds_read_b128 v[160:163], v11 offset:0
    ds_read_b128 v[176:179], v11 offset:512
    ds_read_b128 v[164:167], v11 offset:64
    ds_read_b128 v[180:183], v11 offset:576
    ds_read_b128 v[168:171], v11 offset:128
    ds_read_b128 v[184:187], v11 offset:640
    ds_read_b128 v[172:175], v11 offset:192
    ds_read_b128 v[188:191], v11 offset:704
    v_exp_f32 v112, v112
    v_exp_f32 v113, v113
    v_exp_f32 v114, v114
    v_exp_f32 v115, v115
    v_exp_f32 v116, v116
    v_exp_f32 v117, v117
    v_exp_f32 v118, v118
    v_exp_f32 v119, v119
    s_waitcnt lgkmcnt(7)
    v_mfma_f32_16x16x32_bf16 v[128:131], v[160:163], v[16:19], v[144:147]
    ds_read_b64_tr_b16 v[192:193], v13 offset:0
    ds_read_b64_tr_b16 v[194:195], v13 offset:512
    v_cvt_pk_bf16_f32 v224, v112, v113
    s_waitcnt lgkmcnt(8)
    v_mfma_f32_16x16x32_bf16 v[132:135], v[176:179], v[16:19], v[144:147]
    ds_read_b64_tr_b16 v[196:197], v13 offset:32
    ds_read_b64_tr_b16 v[198:199], v13 offset:544
    v_cvt_pk_bf16_f32 v225, v114, v115
    s_waitcnt lgkmcnt(9)
    v_mfma_f32_16x16x32_bf16 v[128:131], v[164:167], v[20:23], v[128:131]
    ds_read_b64_tr_b16 v[200:201], v13 offset:64
    ds_read_b64_tr_b16 v[202:203], v13 offset:576
    v_cvt_pk_bf16_f32 v226, v116, v117
    s_waitcnt lgkmcnt(10)
    v_mfma_f32_16x16x32_bf16 v[132:135], v[180:183], v[20:23], v[132:135]
    ds_read_b64_tr_b16 v[204:205], v13 offset:96
    ds_read_b64_tr_b16 v[206:207], v13 offset:608
    v_cvt_pk_bf16_f32 v227, v118, v119
    s_waitcnt lgkmcnt(11)
    v_mfma_f32_16x16x32_bf16 v[128:131], v[168:171], v[24:27], v[128:131]
    ds_read_b64_tr_b16 v[208:209], v13 offset:128
    ds_read_b64_tr_b16 v[210:211], v13 offset:640
    v_add_f32 v232, v232, v112
    s_waitcnt lgkmcnt(12)
    v_mfma_f32_16x16x32_bf16 v[132:135], v[184:187], v[24:27], v[132:135]
    ds_read_b64_tr_b16 v[212:213], v13 offset:160
    ds_read_b64_tr_b16 v[214:215], v13 offset:672
    v_add_f32 v232, v232, v113
    s_waitcnt lgkmcnt(13)
    v_mfma_f32_16x16x32_bf16 v[128:131], v[172:175], v[28:31], v[128:131]
    ds_read_b64_tr_b16 v[216:217], v13 offset:192
    ds_read_b64_tr_b16 v[218:219], v13 offset:704
    v_add_f32 v232, v232, v114
    s_waitcnt lgkmcnt(14)
    v_mfma_f32_16x16x32_bf16 v[132:135], v[188:191], v[28:31], v[132:135]
    ds_read_b64_tr_b16 v[220:221], v13 offset:224
    ds_read_b64_tr_b16 v[222:223], v13 offset:736
    v_add_f32 v232, v232, v115
    s_nop 0
    s_waitcnt lgkmcnt(14)
    v_mfma_f32_16x16x32_bf16 v[48:51], v[192:195], v[224:227], v[48:51]
    v_add_f32 v232, v232, v116
    s_add_u32 s34, s97, s87
    s_add_u32 m0, s34, 0
    s_add_u32 s35, s31, 0
    buffer_load_dwordx4 v2, s[48:51], s35 offen nt lds
    s_waitcnt lgkmcnt(12)
    v_mfma_f32_16x16x32_bf16 v[52:55], v[196:199], v[224:227], v[52:55]
    v_add_f32 v232, v232, v117
    s_add_u32 s34, s97, s87
    s_add_u32 m0, s34, 4224
    s_add_u32 s35, s31, 1024
    buffer_load_dwordx4 v2, s[48:51], s35 offen nt lds
    s_waitcnt lgkmcnt(10)
    v_mfma_f32_16x16x32_bf16 v[56:59], v[200:203], v[224:227], v[56:59]
    s_waitcnt lgkmcnt(8)
    v_mfma_f32_16x16x32_bf16 v[60:63], v[204:207], v[224:227], v[60:63]
    v_add_f32 v232, v232, v118
    buffer_load_dword v236, v4, s[40:43], 0 offen sc1
    v_max3_f32 v234, v128, v129, v130
    s_waitcnt lgkmcnt(6)
    v_mfma_f32_16x16x32_bf16 v[64:67], v[208:211], v[224:227], v[64:67]
    v_max3_f32 v235, v131, v132, v133
    s_waitcnt lgkmcnt(4)
    v_mfma_f32_16x16x32_bf16 v[68:71], v[212:215], v[224:227], v[68:71]
    v_add_f32 v232, v232, v119
    s_cmp_lg_u32 s3, 1
    s_cbranch_scc1 L_wt_44
    s_add_u32 s6, s82, 0
    s_and_b32 s6, s6, 3
    s_lshl_b32 s6, s6, 1
    s_add_u32 s6, s6, 1
    s_lshl_b32 s6, s6, 18
    buffer_load_dword v237, v3, s[56:59], s6 offen
L_wt_44:
    v_max3_f32 v234, v234, v134, v135
    s_waitcnt lgkmcnt(2)
    v_mfma_f32_16x16x32_bf16 v[72:75], v[216:219], v[224:227], v[72:75]
    v_max_f32 v234, v234, v235
    s_waitcnt lgkmcnt(0)
    v_mfma_f32_16x16x32_bf16 v[76:79], v[220:223], v[224:227], v[76:79]
    v_cmp_lt_f32 vcc, s100, v234
    s_mov_b32 s97, s96
    s_mov_b32 s96, s98
    s_mov_b32 s31, s30
    s_cbranch_vccnz L_stub_45
L_back_46:
    s_add_u32 s5, s82, 0
    s_and_b32 s5, s5, 3
    s_lshl_b32 s5, s5, 1
    s_add_u32 s5, s5, 0
    s_lshl_b32 s5, s5, 18
    s_lshr_b32 s34, s3, 2
    s_lshl_b32 s35, s34, 16
    s_add_u32 s5, s5, s35
    s_lshl_b32 s86, s84, 10
    s_add_u32 s86, s86, 94208
    s_lshl_b32 s35, s34, 14
    s_add_u32 s87, s86, s35
    s_waitcnt vmcnt(6)
    s_barrier
    s_add_u32 s98, s96, 34304
    s_cmp_eq_u32 s96, 128512
    s_cselect_b32 s98, 0, s98
    s_cmp_eq_u32 s96, 34304
    s_cselect_b32 s98, 94208, s98
    v_add_u32 v11, s98, v10
    v_add_u32 v13, s96, v12
    s_add_u32 s30, s31, 8192
    s_and_b32 s30, s30, 0x1ffff
    ds_read_b128 v[160:163], v11 offset:0
    ds_read_b128 v[176:179], v11 offset:512
    ds_read_b128 v[164:167], v11 offset:64
    ds_read_b128 v[180:183], v11 offset:576
    ds_read_b128 v[168:171], v11 offset:128
    ds_read_b128 v[184:187], v11 offset:640
    ds_read_b128 v[172:175], v11 offset:192
    ds_read_b128 v[188:191], v11 offset:704
    v_exp_f32 v128, v128
    v_exp_f32 v129, v129
    v_exp_f32 v130, v130
    v_exp_f32 v131, v131
    v_exp_f32 v132, v132
    v_exp_f32 v133, v133
    v_exp_f32 v134, v134
    v_exp_f32 v135, v135
    s_waitcnt lgkmcnt(7)
    v_mfma_f32_16x16x32_bf16 v[112:115], v[160:163], v[16:19], v[144:147]
    ds_read_b64_tr_b16 v[192:193], v13 offset:0
    ds_read_b64_tr_b16 v[194:195], v13 offset:512
    v_cvt_pk_bf16_f32 v224, v128, v129
    s_waitcnt lgkmcnt(8)
    v_mfma_f32_16x16x32_bf16 v[116:119], v[176:179], v[16:19], v[144:147]
    ds_read_b64_tr_b16 v[196:197], v13 offset:32
    ds_read_b64_tr_b16 v[198:199], v13 offset:544
    v_cvt_pk_bf16_f32 v225, v130, v131
    s_waitcnt lgkmcnt(9)
    v_mfma_f32_16x16x32_bf16 v[112:115], v[164:167], v[20:23], v[112:115]
    ds_read_b64_tr_b16 v[200:201], v13 offset:64
    ds_read_b64_tr_b16 v[202:203], v13 offset:576
    v_cvt_pk_bf16_f32 v226, v132, v133
    s_waitcnt lgkmcnt(10)
    v_mfma_f32_16x16x32_bf16 v[116:119], v[180:183], v[20:23], v[116:119]
    ds_read_b64_tr_b16 v[204:205], v13 offset:96
    ds_read_b64_tr_b16 v[206:207], v13 offset:608
    v_cvt_pk_bf16_f32 v227, v134, v135
    s_waitcnt lgkmcnt(11)
    v_mfma_f32_16x16x32_bf16 v[112:115], v[168:171], v[24:27], v[112:115]
    ds_read_b64_tr_b16 v[208:209], v13 offset:128
    ds_read_b64_tr_b16 v[210:211], v13 offset:640
    v_add_f32 v232, v232, v128
    s_waitcnt lgkmcnt(12)
    v_mfma_f32_16x16x32_bf16 v[116:119], v[184:187], v[24:27], v[116:119]
    ds_read_b64_tr_b16 v[212:213], v13 offset:160
    ds_read_b64_tr_b16 v[214:215], v13 offset:672
    v_add_f32 v232, v232, v129
    s_waitcnt lgkmcnt(13)
    v_mfma_f32_16x16x32_bf16 v[112:115], v[172:175], v[28:31], v[112:115]
    ds_read_b64_tr_b16 v[216:217], v13 offset:192
    ds_read_b64_tr_b16 v[218:219], v13 offset:704
    v_add_f32 v232, v232, v130
    s_waitcnt lgkmcnt(14)
    v_mfma_f32_16x16x32_bf16 v[116:119], v[188:191], v[28:31], v[116:119]
    ds_read_b64_tr_b16 v[220:221], v13 offset:224
    ds_read_b64_tr_b16 v[222:223], v13 offset:736
    v_add_f32 v232, v232, v131
    s_nop 0
    s_waitcnt lgkmcnt(14)
    v_mfma_f32_16x16x32_bf16 v[48:51], v[192:195], v[224:227], v[48:51]
    v_add_f32 v232, v232, v132
    s_add_u32 m0, s87, 0
    s_add_u32 s35, s5, 0
    buffer_load_dwordx4 v15, s[56:59], s35 offen lds
    s_waitcnt lgkmcnt(12)
    v_mfma_f32_16x16x32_bf16 v[52:55], v[196:199], v[224:227], v[52:55]
    v_add_f32 v232, v232, v133
    s_add_u32 m0, s87, 4096
    s_add_u32 s35, s5, 16384
    buffer_load_dwordx4 v15, s[56:59], s35 offen lds
    s_waitcnt lgkmcnt(10)
    v_mfma_f32_16x16x32_bf16 v[56:59], v[200:203], v[224:227], v[56:59]
    s_waitcnt lgkmcnt(8)
    v_mfma_f32_16x16x32_bf16 v[60:63], v[204:207], v[224:227], v[60:63]
    v_add_f32 v232, v232, v134
    s_add_u32 m0, s87, 8192
    s_add_u32 s35, s5, 32768
    buffer_load_dwordx4 v15, s[56:59], s35 offen lds
    v_max3_f32 v234, v112, v113, v114
    s_waitcnt lgkmcnt(6)
    v_mfma_f32_16x16x32_bf16 v[64:67], v[208:211], v[224:227], v[64:67]
    v_max3_f32 v235, v115, v116, v117
    s_waitcnt lgkmcnt(4)
    v_mfma_f32_16x16x32_bf16 v[68:71], v[212:215], v[224:227], v[68:71]
    v_add_f32 v232, v232, v135
    s_add_u32 m0, s87, 12288
    s_add_u32 s35, s5, 49152
    buffer_load_dwordx4 v15, s[56:59], s35 offen lds
    s_cmp_lg_u32 s3, 2
    s_cbranch_scc1 L_wt_47
    s_add_u32 s6, s82, 1
    s_and_b32 s6, s6, 3
    s_lshl_b32 s6, s6, 1
    s_add_u32 s6, s6, 0
    s_lshl_b32 s6, s6, 18
    buffer_load_dword v237, v3, s[56:59], s6 offen
L_wt_47:
    s_cmp_lg_u32 s3, 3
    s_cbranch_scc1 L_wt_48
    s_add_u32 s6, s82, 2
    s_and_b32 s6, s6, 3
    s_lshl_b32 s6, s6, 1
    s_add_u32 s6, s6, 0
    s_lshl_b32 s6, s6, 18
    buffer_load_dword v237, v3, s[56:59], s6 offen
L_wt_48:
    v_max3_f32 v234, v234, v118, v119
    s_waitcnt lgkmcnt(2)
    v_mfma_f32_16x16x32_bf16 v[72:75], v[216:219], v[224:227], v[72:75]
    v_max_f32 v234, v234, v235
    s_waitcnt lgkmcnt(0)
    v_mfma_f32_16x16x32_bf16 v[76:79], v[220:223], v[224:227], v[76:79]
    v_cmp_lt_f32 vcc, s100, v234
    s_mov_b32 s97, s96
    s_mov_b32 s96, s98
    s_mov_b32 s31, s30
    s_cbranch_vccnz L_stub_49
L_back_50:
    s_waitcnt vmcnt(6)
    s_barrier
    s_add_u32 s98, s96, 34304
    s_cmp_eq_u32 s96, 128512
    s_cselect_b32 s98, 0, s98
    s_cmp_eq_u32 s96, 34304
    s_cselect_b32 s98, 94208, s98
    v_add_u32 v11, s98, v10
    v_add_u32 v13, s96, v12
    s_add_u32 s30, s31, 8192
    s_and_b32 s30, s30, 0x1ffff
    ds_read_b128 v[160:163], v11 offset:0
    ds_read_b128 v[176:179], v11 offset:512
    ds_read_b128 v[164:167], v11 offset:64
    ds_read_b128 v[180:183], v11 offset:576
    ds_read_b128 v[168:171], v11 offset:128
    ds_read_b128 v[184:187], v11 offset:640
    ds_read_b128 v[172:175], v11 offset:192
    ds_read_b128 v[188:191], v11 offset:704
    v_exp_f32 v112, v112
    v_exp_f32 v113, v113
    v_exp_f32 v114, v114
    v_exp_f32 v115, v115
    v_exp_f32 v116, v116
    v_exp_f32 v117, v117
    v_exp_f32 v118, v118
    v_exp_f32 v119, v119
    s_waitcnt lgkmcnt(7)
    v_mfma_f32_16x16x32_bf16 v[128:131], v[160:163], v[16:19], v[144:147]
    ds_read_b64_tr_b16 v[192:193], v13 offset:0
    ds_read_b64_tr_b16 v[194:195], v13 offset:512
    v_cvt_pk_bf16_f32 v224, v112, v113
    s_waitcnt lgkmcnt(8)
    v_mfma_f32_16x16x32_bf16 v[132:135], v[176:179], v[16:19], v[144:147]
    ds_read_b64_tr_b16 v[196:197], v13 offset:32
    ds_read_b64_tr_b16 v[198:199], v13 offset:544
    v_cvt_pk_bf16_f32 v225, v114, v115
    s_waitcnt lgkmcnt(9)
    v_mfma_f32_16x16x32_bf16 v[128:131], v[164:167], v[20:23], v[128:131]
    ds_read_b64_tr_b16 v[200:201], v13 offset:64
    ds_read_b64_tr_b16 v[202:203], v13 offset:576
    v_cvt_pk_bf16_f32 v226, v116, v117
    s_waitcnt lgkmcnt(10)
    v_mfma_f32_16x16x32_bf16 v[132:135], v[180:183], v[20:23], v[132:135]
    ds_read_b64_tr_b16 v[204:205], v13 offset:96
    ds_read_b64_tr_b16 v[206:207], v13 offset:608
    v_cvt_pk_bf16_f32 v227, v118, v119
    s_waitcnt lgkmcnt(11)
    v_mfma_f32_16x16x32_bf16 v[128:131], v[168:171], v[24:27], v[128:131]
    ds_read_b64_tr_b16 v[208:209], v13 offset:128
    ds_read_b64_tr_b16 v[210:211], v13 offset:640
    v_add_f32 v232, v232, v112
    s_waitcnt lgkmcnt(12)
    v_mfma_f32_16x16x32_bf16 v[132:135], v[184:187], v[24:27], v[132:135]
    ds_read_b64_tr_b16 v[212:213], v13 offset:160
    ds_read_b64_tr_b16 v[214:215], v13 offset:672
    v_add_f32 v232, v232, v113
    s_waitcnt lgkmcnt(13)
    v_mfma_f32_16x16x32_bf16 v[128:131], v[172:175], v[28:31], v[128:131]
    ds_read_b64_tr_b16 v[216:217], v13 offset:192
    ds_read_b64_tr_b16 v[218:219], v13 offset:704
    v_add_f32 v232, v232, v114
    s_waitcnt lgkmcnt(14)
    v_mfma_f32_16x16x32_bf16 v[132:135], v[188:191], v[28:31], v[132:135]
    ds_read_b64_tr_b16 v[220:221], v13 offset:224
    ds_read_b64_tr_b16 v[222:223], v13 offset:736
    v_add_f32 v232, v232, v115
    s_nop 0
    s_waitcnt lgkmcnt(14)
    v_mfma_f32_16x16x32_bf16 v[48:51], v[192:195], v[224:227], v[48:51]
    v_add_f32 v232, v232, v116
    s_add_u32 m0, s87, 32768
    s_add_u32 s35, s5, 131072
    buffer_load_dwordx4 v15, s[56:59], s35 offen lds
    s_waitcnt lgkmcnt(12)
    v_mfma_f32_16x16x32_bf16 v[52:55], v[196:199], v[224:227], v[52:55]
    v_add_f32 v232, v232, v117
    s_add_u32 m0, s87, 36864
    s_add_u32 s35, s5, 147456
    buffer_load_dwordx4 v15, s[56:59], s35 offen lds
    s_waitcnt lgkmcnt(10)
    v_mfma_f32_16x16x32_bf16 v[56:59], v[200:203], v[224:227], v[56:59]
    s_waitcnt lgkmcnt(8)
    v_mfma_f32_16x16x32_bf16 v[60:63], v[204:207], v[224:227], v[60:63]
    v_add_f32 v232, v232, v118
    s_add_u32 m0, s87, 40960
    s_add_u32 s35, s5, 163840
    buffer_load_dwordx4 v15, s[56:59], s35 offen lds
    v_max3_f32 v234, v128, v129, v130
    s_waitcnt lgkmcnt(6)
    v_mfma_f32_16x16x32_bf16 v[64:67], v[208:211], v[224:227], v[64:67]
    v_max3_f32 v235, v131, v132, v133
    s_waitcnt lgkmcnt(4)
    v_mfma_f32_16x16x32_bf16 v[68:71], v[212:215], v[224:227], v[68:71]
    v_add_f32 v232, v232, v119
    s_add_u32 m0, s87, 45056
    s_add_u32 s35, s5, 180224
    buffer_load_dwordx4 v15, s[56:59], s35 offen lds
    s_cmp_lg_u32 s3, 4
    s_cbranch_scc1 L_wt_51
    s_add_u32 s6, s82, 3
    s_and_b32 s6, s6, 3
    s_lshl_b32 s6, s6, 1
    s_add_u32 s6, s6, 0
    s_lshl_b32 s6, s6, 18
    buffer_load_dword v237, v3, s[56:59], s6 offen
L_wt_51:
    s_cmp_lg_u32 s3, 5
    s_cbranch_scc1 L_wt_52
    s_add_u32 s6, s82, 1
    s_and_b32 s6, s6, 3
    s_lshl_b32 s6, s6, 1
    s_add_u32 s6, s6, 1
    s_lshl_b32 s6, s6, 18
    buffer_load_dword v237, v3, s[56:59], s6 offen
L_wt_52:
    v_max3_f32 v234, v234, v134, v135
    s_waitcnt lgkmcnt(2)
    v_mfma_f32_16x16x32_bf16 v[72:75], v[216:219], v[224:227], v[72:75]
    v_max_f32 v234, v234, v235
    s_waitcnt lgkmcnt(0)
    v_mfma_f32_16x16x32_bf16 v[76:79], v[220:223], v[224:227], v[76:79]
    v_cmp_lt_f32 vcc, s100, v234
    s_mov_b32 s97, s96
    s_mov_b32 s96, s98
    s_mov_b32 s31, s30
    s_cbranch_vccnz L_stub_53
L_back_54:
    s_waitcnt vmcnt(8)
    s_barrier
    s_add_u32 s98, s96, 34304
    s_cmp_eq_u32 s96, 128512
    s_cselect_b32 s98, 0, s98
    s_cmp_eq_u32 s96, 34304
    s_cselect_b32 s98, 94208, s98
    v_add_u32 v11, s98, v10
    v_add_u32 v13, s96, v12
    s_add_u32 s30, s31, 8192
    s_and_b32 s30, s30, 0x1ffff
    ds_read_b64_tr_b16 v[192:193], v13 offset:0
    ds_read_b64_tr_b16 v[194:195], v13 offset:512
    ds_read_b64_tr_b16 v[196:197], v13 offset:32
    ds_read_b64_tr_b16 v[198:199], v13 offset:544
    ds_read_b64_tr_b16 v[200:201], v13 offset:64
    ds_read_b64_tr_b16 v[202:203], v13 offset:576
    ds_read_b64_tr_b16 v[204:205], v13 offset:96
    ds_read_b64_tr_b16 v[206:207], v13 offset:608
    v_exp_f32 v128, v128
    v_exp_f32 v129, v129
    v_exp_f32 v130, v130
    v_exp_f32 v131, v131
    v_exp_f32 v132, v132
    v_exp_f32 v133, v133
    v_exp_f32 v134, v134
    v_exp_f32 v135, v135
    v_cvt_pk_bf16_f32 v224, v128, v129
    v_cvt_pk_bf16_f32 v225, v130, v131
    v_cvt_pk_bf16_f32 v226, v132, v133
    v_cvt_pk_bf16_f32 v227, v134, v135
    ds_read_b64_tr_b16 v[208:209], v13 offset:128
    ds_read_b64_tr_b16 v[210:211], v13 offset:640
    ds_read_b64_tr_b16 v[212:213], v13 offset:160
    ds_read_b64_tr_b16 v[214:215], v13 offset:672
    ds_read_b64_tr_b16 v[216:217], v13 offset:192
    ds_read_b64_tr_b16 v[218:219], v13 offset:704
    ds_read_b64_tr_b16 v[220:221], v13 offset:224
    ds_read_b64_tr_b16 v[222:223], v13 offset:736
    s_nop 0
    s_waitcnt lgkmcnt(14)
    v_mfma_f32_16x16x32_bf16 v[48:51], v[192:195], v[224:227], v[48:51]
    v_add_f32 v232, v232, v128
    s_cmp_lg_u32 s3, 6
    s_cbranch_scc1 L_wt_55
    s_add_u32 s6, s82, 2
    s_and_b32 s6, s6, 3
    s_lshl_b32 s6, s6, 1
    s_add_u32 s6, s6, 1
    s_lshl_b32 s6, s6, 18
    buffer_load_dword v237, v3, s[56:59], s6 offen
L_wt_55:
    s_cmp_lg_u32 s3, 7
    s_cbranch_scc1 L_wt_56
    s_add_u32 s6, s82, 3
    s_and_b32 s6, s6, 3
    s_lshl_b32 s6, s6, 1
    s_add_u32 s6, s6, 1
    s_lshl_b32 s6, s6, 18
    buffer_load_dword v237, v3, s[56:59], s6 offen
L_wt_56:
    s_waitcnt lgkmcnt(12)
    v_mfma_f32_16x16x32_bf16 v[52:55], v[196:199], v[224:227], v[52:55]
    v_add_f32 v232, v232, v129
    s_waitcnt lgkmcnt(10)
    v_mfma_f32_16x16x32_bf16 v[56:59], v[200:203], v[224:227], v[56:59]
    v_add_f32 v232, v232, v130
    s_waitcnt lgkmcnt(8)
    v_mfma_f32_16x16x32_bf16 v[60:63], v[204:207], v[224:227], v[60:63]
    v_add_f32 v232, v232, v131
    s_waitcnt lgkmcnt(6)
    v_mfma_f32_16x16x32_bf16 v[64:67], v[208:211], v[224:227], v[64:67]
    v_add_f32 v232, v232, v132
    s_waitcnt lgkmcnt(4)
    v_mfma_f32_16x16x32_bf16 v[68:71], v[212:215], v[224:227], v[68:71]
    v_add_f32 v232, v232, v133
    s_waitcnt lgkmcnt(2)
    v_mfma_f32_16x16x32_bf16 v[72:75], v[216:219], v[224:227], v[72:75]
    v_add_f32 v232, v232, v134
    s_waitcnt lgkmcnt(0)
    v_mfma_f32_16x16x32_bf16 v[76:79], v[220:223], v[224:227], v[76:79]
    v_add_f32 v232, v232, v135
    s_nop 0
    v_mov_b32 v235, v232
    s_nop 1
    v_permlane16_swap_b32 v235, v232
    s_nop 1
    v_add_f32 v232, v232, v235
    s_nop 0
    v_mov_b32 v235, v232
    s_nop 1
    v_permlane32_swap_b32 v235, v232
    s_nop 1
    v_add_f32 v232, v232, v235
    v_rcp_f32 v232, v232
    s_mul_i32 s34, s82, 57344
    s_barrier
    s_cmp_ge_u32 s3, 4
    s_cbranch_scc1 L_epx1
    v_pk_mul_f32 v[48:49], v[48:49], v[232:233] op_sel:[0,0] op_sel_hi:[1,0]
    v_pk_mul_f32 v[50:51], v[50:51], v[232:233] op_sel:[0,0] op_sel_hi:[1,0]
    v_pk_mul_f32 v[52:53], v[52:53], v[232:233] op_sel:[0,0] op_sel_hi:[1,0]
    v_pk_mul_f32 v[54:55], v[54:55], v[232:233] op_sel:[0,0] op_sel_hi:[1,0]
    v_cvt_pk_bf16_f32 v48, v48, v49
    v_cvt_pk_bf16_f32 v49, v50, v51
    v_cvt_pk_bf16_f32 v50, v52, v53
    v_cvt_pk_bf16_f32 v51, v54, v55
    ds_write_b128 v14, v[48:51] offset:0
    buffer_store_dwordx4 v[48:51], v14, s[52:55], s34 offen offset:0 sc1
    s_add_u32 s34, s34, 7168
    v_pk_mul_f32 v[56:57], v[56:57], v[232:233] op_sel:[0,0] op_sel_hi:[1,0]
    v_pk_mul_f32 v[58:59], v[58:59], v[232:233] op_sel:[0,0] op_sel_hi:[1,0]
    v_pk_mul_f32 v[60:61], v[60:61], v[232:233] op_sel:[0,0] op_sel_hi:[1,0]
    v_pk_mul_f32 v[62:63], v[62:63], v[232:233] op_sel:[0,0] op_sel_hi:[1,0]
    v_cvt_pk_bf16_f32 v56, v56, v57
    v_cvt_pk_bf16_f32 v57, v58, v59
    v_cvt_pk_bf16_f32 v58, v60, v61
    v_cvt_pk_bf16_f32 v59, v62, v63
    ds_write_b128 v14, v[56:59] offset:7168
    buffer_store_dwordx4 v[56:59], v14, s[52:55], s34 offen offset:0 sc1
    s_add_u32 s34, s34, 7168
    v_pk_mul_f32 v[64:65], v[64:65], v[232:233] op_sel:[0,0] op_sel_hi:[1,0]
    v_pk_mul_f32 v[66:67], v[66:67], v[232:233] op_sel:[0,0] op_sel_hi:[1,0]
    v_pk_mul_f32 v[68:69], v[68:69], v[232:233] op_sel:[0,0] op_sel_hi:[1,0]
    v_pk_mul_f32 v[70:71], v[70:71], v[232:233] op_sel:[0,0] op_sel_hi:[1,0]
    v_cvt_pk_bf16_f32 v64, v64, v65
    v_cvt_pk_bf16_f32 v65, v66, v67
    v_cvt_pk_bf16_f32 v66, v68, v69
    v_cvt_pk_bf16_f32 v67, v70, v71
    ds_write_b128 v14, v[64:67] offset:14336
    buffer_store_dwordx4 v[64:67], v14, s[52:55], s34 offen offset:0 sc1
    s_add_u32 s34, s34, 7168
    v_pk_mul_f32 v[72:73], v[72:73], v[232:233] op_sel:[0,0] op_sel_hi:[1,0]
    v_pk_mul_f32 v[74:75], v[74:75], v[232:233] op_sel:[0,0] op_sel_hi:[1,0]
    v_pk_mul_f32 v[76:77], v[76:77], v[232:233] op_sel:[0,0] op_sel_hi:[1,0]
    v_pk_mul_f32 v[78:79], v[78:79], v[232:233] op_sel:[0,0] op_sel_hi:[1,0]
    v_cvt_pk_bf16_f32 v72, v72, v73
    v_cvt_pk_bf16_f32 v73, v74, v75
    v_cvt_pk_bf16_f32 v74, v76, v77
    v_cvt_pk_bf16_f32 v75, v78, v79
    ds_write_b128 v14, v[72:75] offset:21504
    buffer_store_dwordx4 v[72:75], v14, s[52:55], s34 offen offset:0 sc1
    s_add_u32 s34, s34, 7168
    s_waitcnt vmcnt(4)
    s_branch L_oload
L_epx1:
    v_pk_mul_f32 v[48:49], v[48:49], v[232:233] op_sel:[0,0] op_sel_hi:[1,0]
    v_pk_mul_f32 v[50:51], v[50:51], v[232:233] op_sel:[0,0] op_sel_hi:[1,0]
    v_pk_mul_f32 v[52:53], v[52:53], v[232:233] op_sel:[0,0] op_sel_hi:[1,0]
    v_pk_mul_f32 v[54:55], v[54:55], v[232:233] op_sel:[0,0] op_sel_hi:[1,0]
    v_cvt_pk_bf16_f32 v48, v48, v49
    v_cvt_pk_bf16_f32 v49, v50, v51
    v_cvt_pk_bf16_f32 v50, v52, v53
    v_cvt_pk_bf16_f32 v51, v54, v55
    ds_write_b128 v14, v[48:51] offset:0
    v_pk_mul_f32 v[56:57], v[56:57], v[232:233] op_sel:[0,0] op_sel_hi:[1,0]
    v_pk_mul_f32 v[58:59], v[58:59], v[232:233] op_sel:[0,0] op_sel_hi:[1,0]
    v_pk_mul_f32 v[60:61], v[60:61], v[232:233] op_sel:[0,0] op_sel_hi:[1,0]
    v_pk_mul_f32 v[62:63], v[62:63], v[232:233] op_sel:[0,0] op_sel_hi:[1,0]
    v_cvt_pk_bf16_f32 v56, v56, v57
    v_cvt_pk_bf16_f32 v57, v58, v59
    v_cvt_pk_bf16_f32 v58, v60, v61
    v_cvt_pk_bf16_f32 v59, v62, v63
    ds_write_b128 v14, v[56:59] offset:7168
    v_pk_mul_f32 v[64:65], v[64:65], v[232:233] op_sel:[0,0] op_sel_hi:[1,0]
    v_pk_mul_f32 v[66:67], v[66:67], v[232:233] op_sel:[0,0] op_sel_hi:[1,0]
    v_pk_mul_f32 v[68:69], v[68:69], v[232:233] op_sel:[0,0] op_sel_hi:[1,0]
    v_pk_mul_f32 v[70:71], v[70:71], v[232:233] op_sel:[0,0] op_sel_hi:[1,0]
    v_cvt_pk_bf16_f32 v64, v64, v65
    v_cvt_pk_bf16_f32 v65, v66, v67
    v_cvt_pk_bf16_f32 v66, v68, v69
    v_cvt_pk_bf16_f32 v67, v70, v71
    ds_write_b128 v14, v[64:67] offset:14336
    v_pk_mul_f32 v[72:73], v[72:73], v[232:233] op_sel:[0,0] op_sel_hi:[1,0]
    v_pk_mul_f32 v[74:75], v[74:75], v[232:233] op_sel:[0,0] op_sel_hi:[1,0]
    v_pk_mul_f32 v[76:77], v[76:77], v[232:233] op_sel:[0,0] op_sel_hi:[1,0]
    v_pk_mul_f32 v[78:79], v[78:79], v[232:233] op_sel:[0,0] op_sel_hi:[1,0]
    v_cvt_pk_bf16_f32 v72, v72, v73
    v_cvt_pk_bf16_f32 v73, v74, v75
    v_cvt_pk_bf16_f32 v74, v76, v77
    v_cvt_pk_bf16_f32 v75, v78, v79
    ds_write_b128 v14, v[72:75] offset:21504
    s_branch L_omm
L_oload:
    v_mov_b32 v9, v14
    v_lshlrev_b32 v14, 4, v0
    s_cmp_ge_u32 s3, 2
    s_cbranch_scc1 L_ol2
    v_lshrrev_b32 v4, 5, v0
    s_lshl_b32 s35, s3, 2
    v_add_u32 v4, s35, v4
    v_and_b32 v5, 31, v0
    v_lshlrev_b32 v6, 1, v4
    v_xor_b32 v5, v5, v6
    v_lshlrev_b32 v4, 11, v4
    v_lshl_add_u32 v15, v5, 4, v4
    v_xor_b32 v13, 64, v15
    v_add_u32 v13, 4096, v13
    s_lshl_b32 s86, s3, 11
    s_add_u32 s86, s86, 94208
    s_mov_b32 s85, 1
    s_mov_b32 s101, 8
    s_mov_b32 s92, 0x76532140
    s_mov_b32 s93, 0xf
    s_add_u32 s5, s92, s82
    s_and_b32 s5, s5, 3
    s_bfe_u32 s6, s92, 0x20002
    s_waitcnt lgkmcnt(0)
    s_barrier
L_owl:
    s_lshr_b64 s[92:93], s[92:93], 4
    s_add_u32 s5, s92, s82
    s_and_b32 s5, s5, 3
    s_bfe_u32 s6, s92, 0x20002
    s_lshl_b32 s30, s5, 1
    s_and_b32 s35, s6, 1
    s_add_u32 s30, s30, s35
    s_lshr_b32 s35, s6, 1
    s_lshl_b32 s35, s35, 3
    s_add_u32 s30, s30, s35
    s_lshl_b32 s30, s30, 18
    s_waitcnt vmcnt(16)
    s_barrier
    s_add_u32 m0, s86, 0
    s_add_u32 s35, s30, 0
    buffer_load_dwordx4 v15, s[56:59], s35 offen lds
    s_add_u32 m0, s86, 1024
    s_nop 0
    buffer_load_dwordx4 v13, s[56:59], s35 offen lds
    s_add_u32 m0, s86, 4096
    s_add_u32 s35, s30, 16384
    buffer_load_dwordx4 v15, s[56:59], s35 offen lds
    s_add_u32 m0, s86, 5120
    s_nop 0
    buffer_load_dwordx4 v13, s[56:59], s35 offen lds
    s_add_u32 m0, s86, 8192
    s_add_u32 s35, s30, 32768
    buffer_load_dwordx4 v15, s[56:59], s35 offen lds
    s_add_u32 m0, s86, 9216
    s_nop 0
    buffer_load_dwordx4 v13, s[56:59], s35 offen lds
    s_add_u32 m0, s86, 12288
    s_add_u32 s35, s30, 49152
    buffer_load_dwordx4 v15, s[56:59], s35 offen lds
    s_add_u32 m0, s86, 13312
    s_nop 0
    buffer_load_dwordx4 v13, s[56:59], s35 offen lds
    s_waitcnt vmcnt(16)
    s_barrier
    s_add_u32 m0, s86, 16384
    s_add_u32 s35, s30, 65536
    buffer_load_dwordx4 v15, s[56:59], s35 offen lds
    s_add_u32 m0, s86, 17408
    s_nop 0
    buffer_load_dwordx4 v13, s[56:59], s35 offen lds
    s_add_u32 m0, s86, 20480
    s_add_u32 s35, s30, 81920
    buffer_load_dwordx4 v15, s[56:59], s35 offen lds
    s_add_u32 m0, s86, 21504
    s_nop 0
    buffer_load_dwordx4 v13, s[56:59], s35 offen lds
    s_add_u32 m0, s86, 24576
    s_add_u32 s35, s30, 98304
    buffer_load_dwordx4 v15, s[56:59], s35 offen lds
    s_add_u32 m0, s86, 25600
    s_nop 0
    buffer_load_dwordx4 v13, s[56:59], s35 offen lds
    s_add_u32 m0, s86, 28672
    s_add_u32 s35, s30, 114688
    buffer_load_dwordx4 v15, s[56:59], s35 offen lds
    s_add_u32 m0, s86, 29696
    s_nop 0
    buffer_load_dwordx4 v13, s[56:59], s35 offen lds
    s_waitcnt vmcnt(16)
    s_barrier
    s_add_u32 m0, s86, 32768
    s_add_u32 s35, s30, 131072
    buffer_load_dwordx4 v15, s[56:59], s35 offen lds
    s_add_u32 m0, s86, 33792
    s_nop 0
    buffer_load_dwordx4 v13, s[56:59], s35 offen lds
    s_add_u32 m0, s86, 36864
    s_add_u32 s35, s30, 147456
    buffer_load_dwordx4 v15, s[56:59], s35 offen lds
    s_add_u32 m0, s86, 37888
    s_nop 0
    buffer_load_dwordx4 v13, s[56:59], s35 offen lds
    s_add_u32 m0, s86, 40960
    s_add_u32 s35, s30, 163840
    buffer_load_dwordx4 v15, s[56:59], s35 offen lds
    s_add_u32 m0, s86, 41984
    s_nop 0
    buffer_load_dwordx4 v13, s[56:59], s35 offen lds
    s_add_u32 m0, s86, 45056
    s_add_u32 s35, s30, 180224
    buffer_load_dwordx4 v15, s[56:59], s35 offen lds
    s_add_u32 m0, s86, 46080
    s_nop 0
    buffer_load_dwordx4 v13, s[56:59], s35 offen lds
    s_waitcnt vmcnt(16)
    s_barrier
    s_add_u32 m0, s86, 49152
    s_add_u32 s35, s30, 196608
    buffer_load_dwordx4 v15, s[56:59], s35 offen lds
    s_add_u32 m0, s86, 50176
    s_nop 0
    buffer_load_dwordx4 v13, s[56:59], s35 offen lds
    s_add_u32 m0, s86, 53248
    s_add_u32 s35, s30, 212992
    buffer_load_dwordx4 v15, s[56:59], s35 offen lds
    s_add_u32 m0, s86, 54272
    s_nop 0
    buffer_load_dwordx4 v13, s[56:59], s35 offen lds
    s_add_u32 m0, s86, 57344
    s_add_u32 s35, s30, 229376
    buffer_load_dwordx4 v15, s[56:59], s35 offen lds
    s_add_u32 m0, s86, 58368
    s_nop 0
    buffer_load_dwordx4 v13, s[56:59], s35 offen lds
    s_add_u32 m0, s86, 61440
    s_add_u32 s35, s30, 245760
    buffer_load_dwordx4 v15, s[56:59], s35 offen lds
    s_add_u32 m0, s86, 62464
    s_nop 0
    buffer_load_dwordx4 v13, s[56:59], s35 offen lds
    s_add_u32 s85, s85, 1
    s_cmp_lt_u32 s85, s101
    s_cbranch_scc1 L_owl
    s_waitcnt vmcnt(16)
    s_barrier
    s_waitcnt vmcnt(8)
    s_barrier
    s_waitcnt vmcnt(0)
    s_barrier
    s_barrier
    s_branch L_end
L_ol2:
    s_cmp_eq_u32 s3, 3
    s_cbranch_scc1 L_ol3
    s_mov_b32 s101, 8
    s_mov_b32 s92, 0xf765321
    s_mov_b32 s93, 0x0
    s_add_u32 s5, s92, s82
    s_and_b32 s5, s5, 3
    s_bfe_u32 s6, s92, 0x20002
    s_mov_b32 s85, 2
    s_mov_b32 s33, 0
    s_waitcnt lgkmcnt(0)
    s_barrier
    v_mov_b32 v4, 0
    v_cmp_eq_u32 vcc, 0, v236
    s_cbranch_vccz L_pt_out
    s_mov_b32 s89, 0
L_pt:
    buffer_load_dword v236, v4, s[40:43], 0 offen sc1
    s_add_u32 s89, s89, 1
    s_waitcnt vmcnt(0)
    v_cmp_eq_u32 vcc, 0, v236
    s_cmp_ge_u32 s89, 400000
    s_cbranch_scc1 L_pt_out
    s_cbranch_vccnz L_pt
L_pt_out:
    s_barrier
    s_barrier
    s_waitcnt vmcnt(0)
    s_barrier
    s_barrier
    s_barrier
    s_andn2_b32 s35, s2, 0x18
    s_lshl_b32 s34, s5, 3
    s_or_b32 s35, s35, s34
    s_lshr_b32 s34, s6, 1
    s_add_u32 s35, s35, s34
    s_lshl_b32 s35, s35, 5
    s_and_b32 s34, s6, 1
    s_add_u32 s35, s35, s34
    s_lshl_b32 s35, s35, 2
    s_add_u32 s35, s35, 50331648
    v_mov_b32 v5, s35
    s_mul_i32 s32, s5, 57344
    s_mul_i32 s34, s34, 28672
    s_add_u32 s32, s32, s34
    s_lshr_b32 s34, s6, 1
    s_mul_i32 s34, s34, 229376
    s_add_u32 s32, s32, s34
    buffer_load_dword v13, v5, s[60:63], 0 offen sc1
    s_waitcnt vmcnt(0)
L_ool:
    s_waitcnt vmcnt(7)
    s_barrier
    s_mov_b32 s31, s32
    v_cmp_ne_u32 vcc, v236, v13
    s_cbranch_vccz L_po_out
    s_mov_b32 s89, 0
L_po:
    buffer_load_dword v12, v5, s[60:63], 0 offen sc1
    s_add_u32 s89, s89, 1
    s_waitcnt vmcnt(0)
    v_cmp_ne_u32 vcc, v236, v12
    s_cmp_ge_u32 s89, 400000
    s_cbranch_scc1 L_po_out
    s_cbranch_vccnz L_po
L_po_out:
    s_add_u32 m0, s33, 0
    s_add_u32 s35, s31, 0
    buffer_load_dwordx4 v14, s[52:55], s35 offen offset:0 sc1 lds
    buffer_load_dwordx4 v14, s[52:55], s35 offen offset:1024 sc1 lds
    buffer_load_dwordx4 v14, s[52:55], s35 offen offset:2048 sc1 lds
    buffer_load_dwordx4 v14, s[52:55], s35 offen offset:3072 sc1 lds
    s_add_u32 m0, s33, 4096
    s_add_u32 s35, s31, 4096
    buffer_load_dwordx4 v14, s[52:55], s35 offen offset:0 sc1 lds
    buffer_load_dwordx4 v14, s[52:55], s35 offen offset:1024 sc1 lds
    buffer_load_dwordx4 v14, s[52:55], s35 offen offset:2048 sc1 lds
    s_waitcnt vmcnt(7)
    s_barrier
    s_add_u32 m0, s33, 7168
    s_add_u32 s35, s31, 7168
    buffer_load_dwordx4 v14, s[52:55], s35 offen offset:0 sc1 lds
    buffer_load_dwordx4 v14, s[52:55], s35 offen offset:1024 sc1 lds
    buffer_load_dwordx4 v14, s[52:55], s35 offen offset:2048 sc1 lds
    buffer_load_dwordx4 v14, s[52:55], s35 offen offset:3072 sc1 lds
    s_add_u32 m0, s33, 11264
    s_add_u32 s35, s31, 11264
    buffer_load_dwordx4 v14, s[52:55], s35 offen offset:0 sc1 lds
    buffer_load_dwordx4 v14, s[52:55], s35 offen offset:1024 sc1 lds
    buffer_load_dwordx4 v14, s[52:55], s35 offen offset:2048 sc1 lds
    s_waitcnt vmcnt(7)
    s_barrier
    s_lshr_b64 s[92:93], s[92:93], 4
    s_add_u32 s5, s92, s82
    s_and_b32 s5, s5, 3
    s_bfe_u32 s6, s92, 0x20002
    s_andn2_b32 s35, s2, 0x18
    s_lshl_b32 s34, s5, 3
    s_or_b32 s35, s35, s34
    s_lshr_b32 s34, s6, 1
    s_add_u32 s35, s35, s34
    s_lshl_b32 s35, s35, 5
    s_and_b32 s34, s6, 1
    s_add_u32 s35, s35, s34
    s_lshl_b32 s35, s35, 2
    s_add_u32 s35, s35, 50331648
    v_mov_b32 v5, s35
    s_mul_i32 s32, s5, 57344
    s_mul_i32 s34, s34, 28672
    s_add_u32 s32, s32, s34
    s_lshr_b32 s34, s6, 1
    s_mul_i32 s34, s34, 229376
    s_add_u32 s32, s32, s34
    buffer_load_dword v13, v5, s[60:63], 0 offen sc1
    s_add_u32 m0, s33, 14336
    s_add_u32 s35, s31, 14336
    buffer_load_dwordx4 v14, s[52:55], s35 offen offset:0 sc1 lds
    buffer_load_dwordx4 v14, s[52:55], s35 offen offset:1024 sc1 lds
    buffer_load_dwordx4 v14, s[52:55], s35 offen offset:2048 sc1 lds
    buffer_load_dwordx4 v14, s[52:55], s35 offen offset:3072 sc1 lds
    s_add_u32 m0, s33, 18432
    s_add_u32 s35, s31, 18432
    buffer_load_dwordx4 v14, s[52:55], s35 offen offset:0 sc1 lds
    buffer_load_dwordx4 v14, s[52:55], s35 offen offset:1024 sc1 lds
    buffer_load_dwordx4 v14, s[52:55], s35 offen offset:2048 sc1 lds
    s_waitcnt vmcnt(7)
    s_barrier
    s_add_u32 m0, s33, 21504
    s_add_u32 s35, s31, 21504
    buffer_load_dwordx4 v14, s[52:55], s35 offen offset:0 sc1 lds
    buffer_load_dwordx4 v14, s[52:55], s35 offen offset:1024 sc1 lds
    buffer_load_dwordx4 v14, s[52:55], s35 offen offset:2048 sc1 lds
    buffer_load_dwordx4 v14, s[52:55], s35 offen offset:3072 sc1 lds
    s_add_u32 m0, s33, 25600
    s_add_u32 s35, s31, 25600
    buffer_load_dwordx4 v14, s[52:55], s35 offen offset:0 sc1 lds
    buffer_load_dwordx4 v14, s[52:55], s35 offen offset:1024 sc1 lds
    buffer_load_dwordx4 v14, s[52:55], s35 offen offset:2048 sc1 lds
    s_xor_b32 s33, s33, 28672
    s_add_u32 s85, s85, 1
    s_cmp_lt_u32 s85, s101
    s_cbranch_scc1 L_ool
    s_waitcnt vmcnt(7)
    s_barrier
    s_waitcnt vmcnt(0)
    s_barrier
    s_barrier
    s_branch L_end
L_ol3:
    v_add_u32 v7, 28672, v14
    s_mul_i32 s33, s82, 57344
    s_lshl_b32 s35, s2, 7
    s_add_u32 s35, s35, 50331648
    v_mov_b32 v6, s35
    v_mov_b32 v4, 0
    s_waitcnt lgkmcnt(0)
    s_barrier
    ds_read_b128 v[16:19], v7 offset:0
    ds_read_b128 v[20:23], v7 offset:1024
    ds_read_b128 v[24:27], v7 offset:2048
    ds_read_b128 v[28:31], v7 offset:3072
    ds_read_b128 v[32:35], v7 offset:4096
    ds_read_b128 v[36:39], v7 offset:5120
    ds_read_b128 v[40:43], v7 offset:6144
    ds_read_b128 v[44:47], v7 offset:7168
    ds_read_b128 v[48:51], v7 offset:8192
    ds_read_b128 v[52:55], v7 offset:9216
    ds_read_b128 v[56:59], v7 offset:10240
    ds_read_b128 v[60:63], v7 offset:11264
    ds_read_b128 v[64:67], v7 offset:12288
    ds_read_b128 v[68:71], v7 offset:13312
    ds_read_b128 v[72:75], v7 offset:14336
    ds_read_b128 v[76:79], v7 offset:15360
    ds_read_b128 v[80:83], v7 offset:16384
    ds_read_b128 v[84:87], v7 offset:17408
    ds_read_b128 v[88:91], v7 offset:18432
    ds_read_b128 v[92:95], v7 offset:19456
    ds_read_b128 v[96:99], v7 offset:20480
    ds_read_b128 v[100:103], v7 offset:21504
    ds_read_b128 v[104:107], v7 offset:22528
    ds_read_b128 v[108:111], v7 offset:23552
    ds_read_b128 v[112:115], v7 offset:24576
    ds_read_b128 v[116:119], v7 offset:25600
    ds_read_b128 v[120:123], v7 offset:26624
    ds_read_b128 v[124:127], v7 offset:27648
    v_cmp_eq_u32 vcc, 0, v236
    s_cbranch_vccz L_pt3_out
    s_mov_b32 s89, 0
L_pt3:
    buffer_load_dword v236, v4, s[40:43], 0 offen sc1
    s_add_u32 s89, s89, 1
    s_waitcnt vmcnt(0)
    v_cmp_eq_u32 vcc, 0, v236
    s_cmp_ge_u32 s89, 400000
    s_cbranch_scc1 L_pt3_out
    s_cbranch_vccnz L_pt3
L_pt3_out:
    s_barrier
    s_barrier
    s_waitcnt vmcnt(0)
    s_barrier
    s_mov_b64 exec, 1
    buffer_store_dword v236, v6, s[60:63], 0 offen offset:0 sc1
    s_mov_b64 exec, -1
    s_barrier
    s_barrier
    s_barrier
    s_waitcnt lgkmcnt(0)
    s_add_u32 s34, s33, 0
    buffer_store_dwordx4 v[16:19], v7, s[52:55], s34 offen offset:0 sc1
    buffer_store_dwordx4 v[20:23], v7, s[52:55], s34 offen offset:1024 sc1
    buffer_store_dwordx4 v[24:27], v7, s[52:55], s34 offen offset:2048 sc1
    buffer_store_dwordx4 v[28:31], v7, s[52:55], s34 offen offset:3072 sc1
    s_add_u32 s34, s33, 4096
    buffer_store_dwordx4 v[32:35], v7, s[52:55], s34 offen offset:0 sc1
    buffer_store_dwordx4 v[36:39], v7, s[52:55], s34 offen offset:1024 sc1
    buffer_store_dwordx4 v[40:43], v7, s[52:55], s34 offen offset:2048 sc1
    s_barrier
    buffer_store_dwordx4 v[44:47], v7, s[52:55], s34 offen offset:3072 sc1
    s_add_u32 s34, s33, 8192
    buffer_store_dwordx4 v[48:51], v7, s[52:55], s34 offen offset:0 sc1
    buffer_store_dwordx4 v[52:55], v7, s[52:55], s34 offen offset:1024 sc1
    buffer_store_dwordx4 v[56:59], v7, s[52:55], s34 offen offset:2048 sc1
    buffer_store_dwordx4 v[60:63], v7, s[52:55], s34 offen offset:3072 sc1
    s_add_u32 s34, s33, 12288
    buffer_store_dwordx4 v[64:67], v7, s[52:55], s34 offen offset:0 sc1
    buffer_store_dwordx4 v[68:71], v7, s[52:55], s34 offen offset:1024 sc1
    s_barrier
    buffer_store_dwordx4 v[72:75], v7, s[52:55], s34 offen offset:2048 sc1
    buffer_store_dwordx4 v[76:79], v7, s[52:55], s34 offen offset:3072 sc1
    s_add_u32 s34, s33, 16384
    buffer_store_dwordx4 v[80:83], v7, s[52:55], s34 offen offset:0 sc1
    buffer_store_dwordx4 v[84:87], v7, s[52:55], s34 offen offset:1024 sc1
    buffer_store_dwordx4 v[88:91], v7, s[52:55], s34 offen offset:2048 sc1
    buffer_store_dwordx4 v[92:95], v7, s[52:55], s34 offen offset:3072 sc1
    s_add_u32 s34, s33, 20480
    buffer_store_dwordx4 v[96:99], v7, s[52:55], s34 offen offset:0 sc1
    s_barrier
    buffer_store_dwordx4 v[100:103], v7, s[52:55], s34 offen offset:1024 sc1
    buffer_store_dwordx4 v[104:107], v7, s[52:55], s34 offen offset:2048 sc1
    buffer_store_dwordx4 v[108:111], v7, s[52:55], s34 offen offset:3072 sc1
    s_add_u32 s34, s33, 24576
    buffer_store_dwordx4 v[112:115], v7, s[52:55], s34 offen offset:0 sc1
    buffer_store_dwordx4 v[116:119], v7, s[52:55], s34 offen offset:1024 sc1
    buffer_store_dwordx4 v[120:123], v7, s[52:55], s34 offen offset:2048 sc1
    buffer_store_dwordx4 v[124:127], v7, s[52:55], s34 offen offset:3072 sc1
    s_barrier
    s_barrier
    s_barrier
    s_barrier
    s_waitcnt vmcnt(0)
    s_mov_b64 exec, 1
    buffer_store_dword v236, v6, s[60:63], 0 offen offset:4 sc1
    s_mov_b64 exec, -1
    s_barrier
    s_barrier
    s_barrier
    s_barrier
    s_barrier
    s_barrier
    s_barrier
    s_barrier
    s_barrier
    s_barrier
    s_barrier
    s_barrier
    s_barrier
    s_barrier
    s_barrier
    s_barrier
    s_barrier
    s_barrier
    s_barrier
    s_branch L_end
L_omm:
    v_lshlrev_b32 v14, 4, v0
    s_mov_b32 s101, 8
    v_mov_b32 v4, 0
    s_waitcnt vmcnt(4) lgkmcnt(0)
    s_barrier
    ds_read_b64_tr_b16 v[128:129], v240 offset:0
    ds_read_b64_tr_b16 v[130:131], v240 offset:8192
    ds_read_b128 v[144:147], v14 offset:0
    ds_read_b64_tr_b16 v[132:133], v241 offset:0
    ds_read_b64_tr_b16 v[134:135], v241 offset:8192
    ds_read_b64_tr_b16 v[136:137], v242 offset:0
    ds_read_b64_tr_b16 v[138:139], v242 offset:8192
    ds_read_b64_tr_b16 v[140:141], v243 offset:0
    ds_read_b64_tr_b16 v[142:143], v243 offset:8192
    ds_read_b128 v[148:151], v14 offset:1024
    ds_read_b128 v[152:155], v14 offset:2048
    ds_read_b128 v[156:159], v14 offset:3072
    ds_read_b128 v[160:163], v14 offset:4096
    ds_read_b128 v[164:167], v14 offset:5120
    ds_read_b128 v[168:171], v14 offset:6144
    s_lshl_b32 s30, s80, 3
    s_add_u32 s30, s30, s83
    s_lshl_b32 s30, s30, 2
    s_add_u32 s30, s30, s82
    s_mul_i32 s30, s30, 196608
    s_lshl_b32 s35, s84, 12
    s_add_u32 s30, s30, s35
    s_add_u32 s30, s30, 16777216
    s_mul_i32 s35, s83, 458752
    s_lshl_b32 s34, s80, 11
    s_add_u32 s35, s35, s34
    s_lshl_b32 s34, s82, 9
    s_add_u32 s35, s35, s34
    s_lshl_b32 s34, s81, 7
    s_add_u32 s35, s35, s34
    s_sub_u32 s34, 3670016, s35
    s_add_u32 s36, s24, s35
    s_addc_u32 s37, s25, 0
    s_and_b32 s37, s37, 0xffff
    s_mov_b32 s38, s34
    s_mov_b32 s39, 0x00020000
    s_add_u32 s35, s81, 1
    s_and_b32 s35, s35, 3
    s_mul_i32 s35, s35, 49152
    s_add_u32 s35, s35, s30
    s_add_u32 s5, s35, 0
    s_add_u32 s35, s81, 2
    s_and_b32 s35, s35, 3
    s_mul_i32 s35, s35, 49152
    s_add_u32 s35, s35, s30
    s_add_u32 s6, s35, 16384
    s_add_u32 s35, s81, 3
    s_and_b32 s35, s35, 3
    s_mul_i32 s35, s35, 49152
    s_add_u32 s35, s35, s30
    s_add_u32 s7, s35, 32768
    s_mul_i32 s35, s81, 49152
    s_add_u32 s8, s30, s35
    s_add_u32 s9, s8, 16384
    s_add_u32 s10, s8, 32768
    v_and_b32 v7, 15, v0
    v_lshlrev_b32 v7, 12, v7
    v_lshrrev_b32 v9, 4, v0
    v_lshl_add_u32 v7, v9, 3, v7
    s_lshl_b32 s35, s84, 5
    v_add_u32 v7, s35, v7
    s_lshl_b32 s35, s2, 7
    s_lshl_b32 s34, s84, 2
    s_add_u32 s34, s34, 50331664
    s_add_u32 s35, s35, s34
    v_mov_b32 v5, s35
    v_min_u32 v6, 2, v0
    v_sub_u32 v6, s81, v6
    v_add_u32 v6, -1, v6
    v_and_b32 v6, 3, v6
    s_andn2_b32 s35, s2, 3
    v_or_b32 v6, s35, v6
    v_lshlrev_b32 v6, 7, v6
    v_add_u32 v6, s34, v6
    v_and_b32 v8, 15, v0
    v_bfe_u32 v9, v0, 4, 1
    v_lshl_add_u32 v8, v9, 4, v8
    v_lshlrev_b32 v8, 12, v8
    v_lshrrev_b32 v9, 5, v0
    v_lshl_add_u32 v8, v9, 4, v8
    s_lshl_b32 s35, s84, 5
    v_add_u32 v8, s35, v8
    v_lshlrev_b32 v15, 3, v0
    s_mov_b32 s12, 0x3f80
    s_mov_b32 s13, 0x3f800000
    s_setprio 1
    s_waitcnt lgkmcnt(0)
    s_barrier
    v_mfma_f32_16x16x32_bf16 v[16:19], v[128:131], v[144:147], 0
    ds_read_b64_tr_b16 v[172:173], v240 offset:16384
    v_mfma_f32_16x16x32_bf16 v[44:47], v[132:135], v[144:147], 0
    ds_read_b64_tr_b16 v[174:175], v240 offset:24576
    v_mfma_f32_16x16x32_bf16 v[72:75], v[136:139], v[144:147], 0
    ds_read_b128 v[188:191], v14 offset:7168
    v_mfma_f32_16x16x32_bf16 v[100:103], v[140:143], v[144:147], 0
    ds_read_b64_tr_b16 v[176:177], v241 offset:16384
    v_mfma_f32_16x16x32_bf16 v[104:107], v[140:143], v[148:151], 0
    ds_read_b64_tr_b16 v[178:179], v241 offset:24576
    v_mfma_f32_16x16x32_bf16 v[76:79], v[136:139], v[148:151], 0
    ds_read_b64_tr_b16 v[180:181], v242 offset:16384
    v_mfma_f32_16x16x32_bf16 v[48:51], v[132:135], v[148:151], 0
    ds_read_b64_tr_b16 v[182:183], v242 offset:24576
    v_mfma_f32_16x16x32_bf16 v[20:23], v[128:131], v[148:151], 0
    ds_read_b64_tr_b16 v[184:185], v243 offset:16384
    v_mfma_f32_16x16x32_bf16 v[24:27], v[128:131], v[152:155], 0
    ds_read_b64_tr_b16 v[186:187], v243 offset:24576
    v_mfma_f32_16x16x32_bf16 v[52:55], v[132:135], v[152:155], 0
    ds_read_b128 v[192:195], v14 offset:8192
    v_mfma_f32_16x16x32_bf16 v[80:83], v[136:139], v[152:155], 0
    ds_read_b128 v[196:199], v14 offset:9216
    v_mfma_f32_16x16x32_bf16 v[108:111], v[140:143], v[152:155], 0
    ds_read_b128 v[200:203], v14 offset:10240
    v_mfma_f32_16x16x32_bf16 v[112:115], v[140:143], v[156:159], 0
    ds_read_b128 v[204:207], v14 offset:11264
    v_mfma_f32_16x16x32_bf16 v[84:87], v[136:139], v[156:159], 0
    ds_read_b128 v[208:211], v14 offset:12288
    v_mfma_f32_16x16x32_bf16 v[56:59], v[132:135], v[156:159], 0
    ds_read_b128 v[212:215], v14 offset:13312
    v_mfma_f32_16x16x32_bf16 v[28:31], v[128:131], v[156:159], 0
    v_mfma_f32_16x16x32_bf16 v[32:35], v[128:131], v[160:163], 0
    v_mfma_f32_16x16x32_bf16 v[60:63], v[132:135], v[160:163], 0
    v_mfma_f32_16x16x32_bf16 v[88:91], v[136:139], v[160:163], 0
    v_mfma_f32_16x16x32_bf16 v[116:119], v[140:143], v[160:163], 0
    v_mfma_f32_16x16x32_bf16 v[120:123], v[140:143], v[164:167], 0
    v_mfma_f32_16x16x32_bf16 v[92:95], v[136:139], v[164:167], 0
    v_mfma_f32_16x16x32_bf16 v[64:67], v[132:135], v[164:167], 0
    v_mfma_f32_16x16x32_bf16 v[36:39], v[128:131], v[164:167], 0
    v_mfma_f32_16x16x32_bf16 v[40:43], v[128:131], v[168:171], 0
    v_mfma_f32_16x16x32_bf16 v[68:71], v[132:135], v[168:171], 0
    v_mfma_f32_16x16x32_bf16 v[96:99], v[136:139], v[168:171], 0
    v_mfma_f32_16x16x32_bf16 v[124:127], v[140:143], v[168:171], 0
    s_mov_b32 s85, 0
    s_branch L_o_mid
L_o:
    s_waitcnt lgkmcnt(0)
    s_barrier
    v_mfma_f32_16x16x32_bf16 v[16:19], v[128:131], v[144:147], v[16:19]
    ds_read_b64_tr_b16 v[172:173], v240 offset:16384
    v_mfma_f32_16x16x32_bf16 v[44:47], v[132:135], v[144:147], v[44:47]
    ds_read_b64_tr_b16 v[174:175], v240 offset:24576
    v_mfma_f32_16x16x32_bf16 v[72:75], v[136:139], v[144:147], v[72:75]
    ds_read_b128 v[188:191], v14 offset:7168
    v_mfma_f32_16x16x32_bf16 v[100:103], v[140:143], v[144:147], v[100:103]
    ds_read_b64_tr_b16 v[176:177], v241 offset:16384
    v_mfma_f32_16x16x32_bf16 v[104:107], v[140:143], v[148:151], v[104:107]
    ds_read_b64_tr_b16 v[178:179], v241 offset:24576
    v_mfma_f32_16x16x32_bf16 v[76:79], v[136:139], v[148:151], v[76:79]
    ds_read_b64_tr_b16 v[180:181], v242 offset:16384
    v_mfma_f32_16x16x32_bf16 v[48:51], v[132:135], v[148:151], v[48:51]
    ds_read_b64_tr_b16 v[182:183], v242 offset:24576
    v_mfma_f32_16x16x32_bf16 v[20:23], v[128:131], v[148:151], v[20:23]
    ds_read_b64_tr_b16 v[184:185], v243 offset:16384
    v_mfma_f32_16x16x32_bf16 v[24:27], v[128:131], v[152:155], v[24:27]
    ds_read_b64_tr_b16 v[186:187], v243 offset:24576
    v_mfma_f32_16x16x32_bf16 v[52:55], v[132:135], v[152:155], v[52:55]
    ds_read_b128 v[192:195], v14 offset:8192
    v_mfma_f32_16x16x32_bf16 v[80:83], v[136:139], v[152:155], v[80:83]
    ds_read_b128 v[196:199], v14 offset:9216
    v_mfma_f32_16x16x32_bf16 v[108:111], v[140:143], v[152:155], v[108:111]
    ds_read_b128 v[200:203], v14 offset:10240
    v_mfma_f32_16x16x32_bf16 v[112:115], v[140:143], v[156:159], v[112:115]
    ds_read_b128 v[204:207], v14 offset:11264
    v_mfma_f32_16x16x32_bf16 v[84:87], v[136:139], v[156:159], v[84:87]
    ds_read_b128 v[208:211], v14 offset:12288
    v_mfma_f32_16x16x32_bf16 v[56:59], v[132:135], v[156:159], v[56:59]
    ds_read_b128 v[212:215], v14 offset:13312
    v_mfma_f32_16x16x32_bf16 v[28:31], v[128:131], v[156:159], v[28:31]
    v_mfma_f32_16x16x32_bf16 v[32:35], v[128:131], v[160:163], v[32:35]
    v_mfma_f32_16x16x32_bf16 v[60:63], v[132:135], v[160:163], v[60:63]
    v_mfma_f32_16x16x32_bf16 v[88:91], v[136:139], v[160:163], v[88:91]
    v_mfma_f32_16x16x32_bf16 v[116:119], v[140:143], v[160:163], v[116:119]
    v_mfma_f32_16x16x32_bf16 v[120:123], v[140:143], v[164:167], v[120:123]
    v_mfma_f32_16x16x32_bf16 v[92:95], v[136:139], v[164:167], v[92:95]
    v_mfma_f32_16x16x32_bf16 v[64:67], v[132:135], v[164:167], v[64:67]
    v_mfma_f32_16x16x32_bf16 v[36:39], v[128:131], v[164:167], v[36:39]
    v_mfma_f32_16x16x32_bf16 v[40:43], v[128:131], v[168:171], v[40:43]
    v_mfma_f32_16x16x32_bf16 v[68:71], v[132:135], v[168:171], v[68:71]
    v_mfma_f32_16x16x32_bf16 v[96:99], v[136:139], v[168:171], v[96:99]
    v_mfma_f32_16x16x32_bf16 v[124:127], v[140:143], v[168:171], v[124:127]
L_o_mid:
    s_waitcnt lgkmcnt(0)
    s_barrier
    v_mfma_f32_16x16x32_bf16 v[16:19], v[172:175], v[188:191], v[16:19]
    ds_read_b64_tr_b16 v[128:129], v240 offset:32768
    v_mfma_f32_16x16x32_bf16 v[44:47], v[176:179], v[188:191], v[44:47]
    ds_read_b64_tr_b16 v[130:131], v240 offset:40960
    v_mfma_f32_16x16x32_bf16 v[72:75], v[180:183], v[188:191], v[72:75]
    ds_read_b128 v[144:147], v14 offset:14336
    v_mfma_f32_16x16x32_bf16 v[100:103], v[184:187], v[188:191], v[100:103]
    ds_read_b64_tr_b16 v[132:133], v241 offset:32768
    v_mfma_f32_16x16x32_bf16 v[104:107], v[184:187], v[192:195], v[104:107]
    ds_read_b64_tr_b16 v[134:135], v241 offset:40960
    v_mfma_f32_16x16x32_bf16 v[76:79], v[180:183], v[192:195], v[76:79]
    ds_read_b64_tr_b16 v[136:137], v242 offset:32768
    v_mfma_f32_16x16x32_bf16 v[48:51], v[176:179], v[192:195], v[48:51]
    ds_read_b64_tr_b16 v[138:139], v242 offset:40960
    v_mfma_f32_16x16x32_bf16 v[20:23], v[172:175], v[192:195], v[20:23]
    ds_read_b64_tr_b16 v[140:141], v243 offset:32768
    v_mfma_f32_16x16x32_bf16 v[24:27], v[172:175], v[196:199], v[24:27]
    ds_read_b64_tr_b16 v[142:143], v243 offset:40960
    v_mfma_f32_16x16x32_bf16 v[52:55], v[176:179], v[196:199], v[52:55]
    ds_read_b128 v[148:151], v14 offset:15360
    v_mfma_f32_16x16x32_bf16 v[80:83], v[180:183], v[196:199], v[80:83]
    ds_read_b128 v[152:155], v14 offset:16384
    v_mfma_f32_16x16x32_bf16 v[108:111], v[184:187], v[196:199], v[108:111]
    ds_read_b128 v[156:159], v14 offset:17408
    v_mfma_f32_16x16x32_bf16 v[112:115], v[184:187], v[200:203], v[112:115]
    ds_read_b128 v[160:163], v14 offset:18432
    v_mfma_f32_16x16x32_bf16 v[84:87], v[180:183], v[200:203], v[84:87]
    ds_read_b128 v[164:167], v14 offset:19456
    v_mfma_f32_16x16x32_bf16 v[56:59], v[176:179], v[200:203], v[56:59]
    ds_read_b128 v[168:171], v14 offset:20480
    v_mfma_f32_16x16x32_bf16 v[28:31], v[172:175], v[200:203], v[28:31]
    v_mfma_f32_16x16x32_bf16 v[32:35], v[172:175], v[204:207], v[32:35]
    v_mfma_f32_16x16x32_bf16 v[60:63], v[176:179], v[204:207], v[60:63]
    v_mfma_f32_16x16x32_bf16 v[88:91], v[180:183], v[204:207], v[88:91]
    v_mfma_f32_16x16x32_bf16 v[116:119], v[184:187], v[204:207], v[116:119]
    v_mfma_f32_16x16x32_bf16 v[120:123], v[184:187], v[208:211], v[120:123]
    v_mfma_f32_16x16x32_bf16 v[92:95], v[180:183], v[208:211], v[92:95]
    v_mfma_f32_16x16x32_bf16 v[64:67], v[176:179], v[208:211], v[64:67]
    v_mfma_f32_16x16x32_bf16 v[36:39], v[172:175], v[208:211], v[36:39]
    v_mfma_f32_16x16x32_bf16 v[40:43], v[172:175], v[212:215], v[40:43]
    v_mfma_f32_16x16x32_bf16 v[68:71], v[176:179], v[212:215], v[68:71]
    v_mfma_f32_16x16x32_bf16 v[96:99], v[180:183], v[212:215], v[96:99]
    v_mfma_f32_16x16x32_bf16 v[124:127], v[184:187], v[212:215], v[124:127]
    s_waitcnt lgkmcnt(0) vmcnt(0)
    s_barrier
    v_mfma_f32_16x16x32_bf16 v[16:19], v[128:131], v[144:147], v[16:19]
    ds_read_b64_tr_b16 v[172:173], v240 offset:49152
    v_mfma_f32_16x16x32_bf16 v[44:47], v[132:135], v[144:147], v[44:47]
    ds_read_b64_tr_b16 v[174:175], v240 offset:57344
    v_mfma_f32_16x16x32_bf16 v[72:75], v[136:139], v[144:147], v[72:75]
    ds_read_b128 v[188:191], v14 offset:21504
    v_mfma_f32_16x16x32_bf16 v[100:103], v[140:143], v[144:147], v[100:103]
    ds_read_b64_tr_b16 v[176:177], v241 offset:49152
    v_mfma_f32_16x16x32_bf16 v[104:107], v[140:143], v[148:151], v[104:107]
    ds_read_b64_tr_b16 v[178:179], v241 offset:57344
    v_mfma_f32_16x16x32_bf16 v[76:79], v[136:139], v[148:151], v[76:79]
    ds_read_b64_tr_b16 v[180:181], v242 offset:49152
    v_mfma_f32_16x16x32_bf16 v[48:51], v[132:135], v[148:151], v[48:51]
    ds_read_b64_tr_b16 v[182:183], v242 offset:57344
    v_mfma_f32_16x16x32_bf16 v[20:23], v[128:131], v[148:151], v[20:23]
    ds_read_b64_tr_b16 v[184:185], v243 offset:49152
    v_mfma_f32_16x16x32_bf16 v[24:27], v[128:131], v[152:155], v[24:27]
    ds_read_b64_tr_b16 v[186:187], v243 offset:57344
    v_mfma_f32_16x16x32_bf16 v[52:55], v[132:135], v[152:155], v[52:55]
    ds_read_b128 v[192:195], v14 offset:22528
    v_mfma_f32_16x16x32_bf16 v[80:83], v[136:139], v[152:155], v[80:83]
    ds_read_b128 v[196:199], v14 offset:23552
    v_mfma_f32_16x16x32_bf16 v[108:111], v[140:143], v[152:155], v[108:111]
    ds_read_b128 v[200:203], v14 offset:24576
    v_mfma_f32_16x16x32_bf16 v[112:115], v[140:143], v[156:159], v[112:115]
    ds_read_b128 v[204:207], v14 offset:25600
    v_mfma_f32_16x16x32_bf16 v[84:87], v[136:139], v[156:159], v[84:87]
    ds_read_b128 v[208:211], v14 offset:26624
    v_mfma_f32_16x16x32_bf16 v[56:59], v[132:135], v[156:159], v[56:59]
    ds_read_b128 v[212:215], v14 offset:27648
    v_mfma_f32_16x16x32_bf16 v[28:31], v[128:131], v[156:159], v[28:31]
    v_mfma_f32_16x16x32_bf16 v[32:35], v[128:131], v[160:163], v[32:35]
    v_mfma_f32_16x16x32_bf16 v[60:63], v[132:135], v[160:163], v[60:63]
    v_mfma_f32_16x16x32_bf16 v[88:91], v[136:139], v[160:163], v[88:91]
    v_mfma_f32_16x16x32_bf16 v[116:119], v[140:143], v[160:163], v[116:119]
    v_mfma_f32_16x16x32_bf16 v[120:123], v[140:143], v[164:167], v[120:123]
    v_mfma_f32_16x16x32_bf16 v[92:95], v[136:139], v[164:167], v[92:95]
    v_mfma_f32_16x16x32_bf16 v[64:67], v[132:135], v[164:167], v[64:67]
    v_mfma_f32_16x16x32_bf16 v[36:39], v[128:131], v[164:167], v[36:39]
    v_mfma_f32_16x16x32_bf16 v[40:43], v[128:131], v[168:171], v[40:43]
    v_mfma_f32_16x16x32_bf16 v[68:71], v[132:135], v[168:171], v[68:71]
    v_mfma_f32_16x16x32_bf16 v[96:99], v[136:139], v[168:171], v[96:99]
    v_mfma_f32_16x16x32_bf16 v[124:127], v[140:143], v[168:171], v[124:127]
    s_waitcnt lgkmcnt(0)
    s_barrier
    v_mfma_f32_16x16x32_bf16 v[16:19], v[172:175], v[188:191], v[16:19]
    ds_read_b64_tr_b16 v[128:129], v240 offset:0
    v_mfma_f32_16x16x32_bf16 v[44:47], v[176:179], v[188:191], v[44:47]
    ds_read_b64_tr_b16 v[130:131], v240 offset:8192
    v_mfma_f32_16x16x32_bf16 v[72:75], v[180:183], v[188:191], v[72:75]
    ds_read_b128 v[144:147], v14 offset:28672
    v_mfma_f32_16x16x32_bf16 v[100:103], v[184:187], v[188:191], v[100:103]
    ds_read_b64_tr_b16 v[132:133], v241 offset:0
    v_mfma_f32_16x16x32_bf16 v[104:107], v[184:187], v[192:195], v[104:107]
    ds_read_b64_tr_b16 v[134:135], v241 offset:8192
    v_mfma_f32_16x16x32_bf16 v[76:79], v[180:183], v[192:195], v[76:79]
    ds_read_b64_tr_b16 v[136:137], v242 offset:0
    v_mfma_f32_16x16x32_bf16 v[48:51], v[176:179], v[192:195], v[48:51]
    ds_read_b64_tr_b16 v[138:139], v242 offset:8192
    v_mfma_f32_16x16x32_bf16 v[20:23], v[172:175], v[192:195], v[20:23]
    ds_read_b64_tr_b16 v[140:141], v243 offset:0
    v_mfma_f32_16x16x32_bf16 v[24:27], v[172:175], v[196:199], v[24:27]
    ds_read_b64_tr_b16 v[142:143], v243 offset:8192
    v_mfma_f32_16x16x32_bf16 v[52:55], v[176:179], v[196:199], v[52:55]
    ds_read_b128 v[148:151], v14 offset:29696
    v_mfma_f32_16x16x32_bf16 v[80:83], v[180:183], v[196:199], v[80:83]
    ds_read_b128 v[152:155], v14 offset:30720
    v_mfma_f32_16x16x32_bf16 v[108:111], v[184:187], v[196:199], v[108:111]
    ds_read_b128 v[156:159], v14 offset:31744
    v_mfma_f32_16x16x32_bf16 v[112:115], v[184:187], v[200:203], v[112:115]
    ds_read_b128 v[160:163], v14 offset:32768
    v_mfma_f32_16x16x32_bf16 v[84:87], v[180:183], v[200:203], v[84:87]
    ds_read_b128 v[164:167], v14 offset:33792
    v_mfma_f32_16x16x32_bf16 v[56:59], v[176:179], v[200:203], v[56:59]
    ds_read_b128 v[168:171], v14 offset:34816
    v_mfma_f32_16x16x32_bf16 v[28:31], v[172:175], v[200:203], v[28:31]
    v_mfma_f32_16x16x32_bf16 v[32:35], v[172:175], v[204:207], v[32:35]
    v_mfma_f32_16x16x32_bf16 v[60:63], v[176:179], v[204:207], v[60:63]
    v_mfma_f32_16x16x32_bf16 v[88:91], v[180:183], v[204:207], v[88:91]
    v_mfma_f32_16x16x32_bf16 v[116:119], v[184:187], v[204:207], v[116:119]
    v_mfma_f32_16x16x32_bf16 v[120:123], v[184:187], v[208:211], v[120:123]
    v_mfma_f32_16x16x32_bf16 v[92:95], v[180:183], v[208:211], v[92:95]
    v_mfma_f32_16x16x32_bf16 v[64:67], v[176:179], v[208:211], v[64:67]
    v_mfma_f32_16x16x32_bf16 v[36:39], v[172:175], v[208:211], v[36:39]
    v_mfma_f32_16x16x32_bf16 v[40:43], v[172:175], v[212:215], v[40:43]
    v_mfma_f32_16x16x32_bf16 v[68:71], v[176:179], v[212:215], v[68:71]
    v_mfma_f32_16x16x32_bf16 v[96:99], v[180:183], v[212:215], v[96:99]
    v_mfma_f32_16x16x32_bf16 v[124:127], v[184:187], v[212:215], v[124:127]
    s_add_u32 s85, s85, 1
    s_cmp_lt_u32 s85, s101
    s_cbranch_scc0 L_o_out
    s_waitcnt lgkmcnt(0)
    s_barrier
    v_mfma_f32_16x16x32_bf16 v[16:19], v[128:131], v[144:147], v[16:19]
    ds_read_b64_tr_b16 v[172:173], v240 offset:16384
    v_mfma_f32_16x16x32_bf16 v[44:47], v[132:135], v[144:147], v[44:47]
    ds_read_b64_tr_b16 v[174:175], v240 offset:24576
    v_mfma_f32_16x16x32_bf16 v[72:75], v[136:139], v[144:147], v[72:75]
    ds_read_b128 v[188:191], v14 offset:35840
    v_mfma_f32_16x16x32_bf16 v[100:103], v[140:143], v[144:147], v[100:103]
    ds_read_b64_tr_b16 v[176:177], v241 offset:16384
    v_mfma_f32_16x16x32_bf16 v[104:107], v[140:143], v[148:151], v[104:107]
    ds_read_b64_tr_b16 v[178:179], v241 offset:24576
    v_mfma_f32_16x16x32_bf16 v[76:79], v[136:139], v[148:151], v[76:79]
    ds_read_b64_tr_b16 v[180:181], v242 offset:16384
    v_mfma_f32_16x16x32_bf16 v[48:51], v[132:135], v[148:151], v[48:51]
    ds_read_b64_tr_b16 v[182:183], v242 offset:24576
    v_mfma_f32_16x16x32_bf16 v[20:23], v[128:131], v[148:151], v[20:23]
    ds_read_b64_tr_b16 v[184:185], v243 offset:16384
    v_mfma_f32_16x16x32_bf16 v[24:27], v[128:131], v[152:155], v[24:27]
    ds_read_b64_tr_b16 v[186:187], v243 offset:24576
    v_mfma_f32_16x16x32_bf16 v[52:55], v[132:135], v[152:155], v[52:55]
    ds_read_b128 v[192:195], v14 offset:36864
    v_mfma_f32_16x16x32_bf16 v[80:83], v[136:139], v[152:155], v[80:83]
    ds_read_b128 v[196:199], v14 offset:37888
    v_mfma_f32_16x16x32_bf16 v[108:111], v[140:143], v[152:155], v[108:111]
    ds_read_b128 v[200:203], v14 offset:38912
    v_mfma_f32_16x16x32_bf16 v[112:115], v[140:143], v[156:159], v[112:115]
    ds_read_b128 v[204:207], v14 offset:39936
    v_mfma_f32_16x16x32_bf16 v[84:87], v[136:139], v[156:159], v[84:87]
    ds_read_b128 v[208:211], v14 offset:40960
    v_mfma_f32_16x16x32_bf16 v[56:59], v[132:135], v[156:159], v[56:59]
    ds_read_b128 v[212:215], v14 offset:41984
    v_mfma_f32_16x16x32_bf16 v[28:31], v[128:131], v[156:159], v[28:31]
    v_mfma_f32_16x16x32_bf16 v[32:35], v[128:131], v[160:163], v[32:35]
    v_mfma_f32_16x16x32_bf16 v[60:63], v[132:135], v[160:163], v[60:63]
    v_mfma_f32_16x16x32_bf16 v[88:91], v[136:139], v[160:163], v[88:91]
    v_mfma_f32_16x16x32_bf16 v[116:119], v[140:143], v[160:163], v[116:119]
    v_mfma_f32_16x16x32_bf16 v[120:123], v[140:143], v[164:167], v[120:123]
    v_mfma_f32_16x16x32_bf16 v[92:95], v[136:139], v[164:167], v[92:95]
    v_mfma_f32_16x16x32_bf16 v[64:67], v[132:135], v[164:167], v[64:67]
    v_mfma_f32_16x16x32_bf16 v[36:39], v[128:131], v[164:167], v[36:39]
    v_mfma_f32_16x16x32_bf16 v[40:43], v[128:131], v[168:171], v[40:43]
    v_mfma_f32_16x16x32_bf16 v[68:71], v[132:135], v[168:171], v[68:71]
    v_mfma_f32_16x16x32_bf16 v[96:99], v[136:139], v[168:171], v[96:99]
    v_mfma_f32_16x16x32_bf16 v[124:127], v[140:143], v[168:171], v[124:127]
    s_waitcnt lgkmcnt(0)
    s_barrier
    v_mfma_f32_16x16x32_bf16 v[16:19], v[172:175], v[188:191], v[16:19]
    ds_read_b64_tr_b16 v[128:129], v240 offset:32768
    v_mfma_f32_16x16x32_bf16 v[44:47], v[176:179], v[188:191], v[44:47]
    ds_read_b64_tr_b16 v[130:131], v240 offset:40960
    v_mfma_f32_16x16x32_bf16 v[72:75], v[180:183], v[188:191], v[72:75]
    ds_read_b128 v[144:147], v14 offset:43008
    v_mfma_f32_16x16x32_bf16 v[100:103], v[184:187], v[188:191], v[100:103]
    ds_read_b64_tr_b16 v[132:133], v241 offset:32768
    v_mfma_f32_16x16x32_bf16 v[104:107], v[184:187], v[192:195], v[104:107]
    ds_read_b64_tr_b16 v[134:135], v241 offset:40960
    v_mfma_f32_16x16x32_bf16 v[76:79], v[180:183], v[192:195], v[76:79]
    ds_read_b64_tr_b16 v[136:137], v242 offset:32768
    v_mfma_f32_16x16x32_bf16 v[48:51], v[176:179], v[192:195], v[48:51]
    ds_read_b64_tr_b16 v[138:139], v242 offset:40960
    v_mfma_f32_16x16x32_bf16 v[20:23], v[172:175], v[192:195], v[20:23]
    ds_read_b64_tr_b16 v[140:141], v243 offset:32768
    v_mfma_f32_16x16x32_bf16 v[24:27], v[172:175], v[196:199], v[24:27]
    ds_read_b64_tr_b16 v[142:143], v243 offset:40960
    v_mfma_f32_16x16x32_bf16 v[52:55], v[176:179], v[196:199], v[52:55]
    ds_read_b128 v[148:151], v14 offset:44032
    v_mfma_f32_16x16x32_bf16 v[80:83], v[180:183], v[196:199], v[80:83]
    ds_read_b128 v[152:155], v14 offset:45056
    v_mfma_f32_16x16x32_bf16 v[108:111], v[184:187], v[196:199], v[108:111]
    ds_read_b128 v[156:159], v14 offset:46080
    v_mfma_f32_16x16x32_bf16 v[112:115], v[184:187], v[200:203], v[112:115]
    ds_read_b128 v[160:163], v14 offset:47104
    v_mfma_f32_16x16x32_bf16 v[84:87], v[180:183], v[200:203], v[84:87]
    ds_read_b128 v[164:167], v14 offset:48128
    v_mfma_f32_16x16x32_bf16 v[56:59], v[176:179], v[200:203], v[56:59]
    ds_read_b128 v[168:171], v14 offset:49152
    v_mfma_f32_16x16x32_bf16 v[28:31], v[172:175], v[200:203], v[28:31]
    v_mfma_f32_16x16x32_bf16 v[32:35], v[172:175], v[204:207], v[32:35]
    v_mfma_f32_16x16x32_bf16 v[60:63], v[176:179], v[204:207], v[60:63]
    v_mfma_f32_16x16x32_bf16 v[88:91], v[180:183], v[204:207], v[88:91]
    v_mfma_f32_16x16x32_bf16 v[116:119], v[184:187], v[204:207], v[116:119]
    v_mfma_f32_16x16x32_bf16 v[120:123], v[184:187], v[208:211], v[120:123]
    v_mfma_f32_16x16x32_bf16 v[92:95], v[180:183], v[208:211], v[92:95]
    v_mfma_f32_16x16x32_bf16 v[64:67], v[176:179], v[208:211], v[64:67]
    v_mfma_f32_16x16x32_bf16 v[36:39], v[172:175], v[208:211], v[36:39]
    v_mfma_f32_16x16x32_bf16 v[40:43], v[172:175], v[212:215], v[40:43]
    v_mfma_f32_16x16x32_bf16 v[68:71], v[176:179], v[212:215], v[68:71]
    v_mfma_f32_16x16x32_bf16 v[96:99], v[180:183], v[212:215], v[96:99]
    v_mfma_f32_16x16x32_bf16 v[124:127], v[184:187], v[212:215], v[124:127]
    s_waitcnt lgkmcnt(0)
    s_barrier
    v_mfma_f32_16x16x32_bf16 v[16:19], v[128:131], v[144:147], v[16:19]
    ds_read_b64_tr_b16 v[172:173], v240 offset:49152
    v_mfma_f32_16x16x32_bf16 v[44:47], v[132:135], v[144:147], v[44:47]
    ds_read_b64_tr_b16 v[174:175], v240 offset:57344
    v_mfma_f32_16x16x32_bf16 v[72:75], v[136:139], v[144:147], v[72:75]
    ds_read_b128 v[188:191], v14 offset:50176
    v_mfma_f32_16x16x32_bf16 v[100:103], v[140:143], v[144:147], v[100:103]
    ds_read_b64_tr_b16 v[176:177], v241 offset:49152
    v_mfma_f32_16x16x32_bf16 v[104:107], v[140:143], v[148:151], v[104:107]
    ds_read_b64_tr_b16 v[178:179], v241 offset:57344
    v_mfma_f32_16x16x32_bf16 v[76:79], v[136:139], v[148:151], v[76:79]
    ds_read_b64_tr_b16 v[180:181], v242 offset:49152
    v_mfma_f32_16x16x32_bf16 v[48:51], v[132:135], v[148:151], v[48:51]
    ds_read_b64_tr_b16 v[182:183], v242 offset:57344
    v_mfma_f32_16x16x32_bf16 v[20:23], v[128:131], v[148:151], v[20:23]
    ds_read_b64_tr_b16 v[184:185], v243 offset:49152
    v_mfma_f32_16x16x32_bf16 v[24:27], v[128:131], v[152:155], v[24:27]
    ds_read_b64_tr_b16 v[186:187], v243 offset:57344
    v_mfma_f32_16x16x32_bf16 v[52:55], v[132:135], v[152:155], v[52:55]
    ds_read_b128 v[192:195], v14 offset:51200
    v_mfma_f32_16x16x32_bf16 v[80:83], v[136:139], v[152:155], v[80:83]
    ds_read_b128 v[196:199], v14 offset:52224
    v_mfma_f32_16x16x32_bf16 v[108:111], v[140:143], v[152:155], v[108:111]
    ds_read_b128 v[200:203], v14 offset:53248
    v_mfma_f32_16x16x32_bf16 v[112:115], v[140:143], v[156:159], v[112:115]
    ds_read_b128 v[204:207], v14 offset:54272
    v_mfma_f32_16x16x32_bf16 v[84:87], v[136:139], v[156:159], v[84:87]
    ds_read_b128 v[208:211], v14 offset:55296
    v_mfma_f32_16x16x32_bf16 v[56:59], v[132:135], v[156:159], v[56:59]
    ds_read_b128 v[212:215], v14 offset:56320
    v_mfma_f32_16x16x32_bf16 v[28:31], v[128:131], v[156:159], v[28:31]
    v_mfma_f32_16x16x32_bf16 v[32:35], v[128:131], v[160:163], v[32:35]
    v_mfma_f32_16x16x32_bf16 v[60:63], v[132:135], v[160:163], v[60:63]
    v_mfma_f32_16x16x32_bf16 v[88:91], v[136:139], v[160:163], v[88:91]
    v_mfma_f32_16x16x32_bf16 v[116:119], v[140:143], v[160:163], v[116:119]
    v_mfma_f32_16x16x32_bf16 v[120:123], v[140:143], v[164:167], v[120:123]
    v_mfma_f32_16x16x32_bf16 v[92:95], v[136:139], v[164:167], v[92:95]
    v_mfma_f32_16x16x32_bf16 v[64:67], v[132:135], v[164:167], v[64:67]
    v_mfma_f32_16x16x32_bf16 v[36:39], v[128:131], v[164:167], v[36:39]
    v_mfma_f32_16x16x32_bf16 v[40:43], v[128:131], v[168:171], v[40:43]
    v_mfma_f32_16x16x32_bf16 v[68:71], v[132:135], v[168:171], v[68:71]
    v_mfma_f32_16x16x32_bf16 v[96:99], v[136:139], v[168:171], v[96:99]
    v_mfma_f32_16x16x32_bf16 v[124:127], v[140:143], v[168:171], v[124:127]
    s_waitcnt lgkmcnt(0)
    s_barrier
    v_mfma_f32_16x16x32_bf16 v[16:19], v[172:175], v[188:191], v[16:19]
    ds_read_b64_tr_b16 v[128:129], v240 offset:0
    v_mfma_f32_16x16x32_bf16 v[44:47], v[176:179], v[188:191], v[44:47]
    ds_read_b64_tr_b16 v[130:131], v240 offset:8192
    v_mfma_f32_16x16x32_bf16 v[72:75], v[180:183], v[188:191], v[72:75]
    ds_read_b128 v[144:147], v14 offset:0
    v_mfma_f32_16x16x32_bf16 v[100:103], v[184:187], v[188:191], v[100:103]
    ds_read_b64_tr_b16 v[132:133], v241 offset:0
    v_mfma_f32_16x16x32_bf16 v[104:107], v[184:187], v[192:195], v[104:107]
    ds_read_b64_tr_b16 v[134:135], v241 offset:8192
    v_mfma_f32_16x16x32_bf16 v[76:79], v[180:183], v[192:195], v[76:79]
    ds_read_b64_tr_b16 v[136:137], v242 offset:0
    v_mfma_f32_16x16x32_bf16 v[48:51], v[176:179], v[192:195], v[48:51]
    ds_read_b64_tr_b16 v[138:139], v242 offset:8192
    v_mfma_f32_16x16x32_bf16 v[20:23], v[172:175], v[192:195], v[20:23]
    ds_read_b64_tr_b16 v[140:141], v243 offset:0
    v_mfma_f32_16x16x32_bf16 v[24:27], v[172:175], v[196:199], v[24:27]
    ds_read_b64_tr_b16 v[142:143], v243 offset:8192
    v_mfma_f32_16x16x32_bf16 v[52:55], v[176:179], v[196:199], v[52:55]
    ds_read_b128 v[148:151], v14 offset:1024
    v_mfma_f32_16x16x32_bf16 v[80:83], v[180:183], v[196:199], v[80:83]
    ds_read_b128 v[152:155], v14 offset:2048
    v_mfma_f32_16x16x32_bf16 v[108:111], v[184:187], v[196:199], v[108:111]
    ds_read_b128 v[156:159], v14 offset:3072
    v_mfma_f32_16x16x32_bf16 v[112:115], v[184:187], v[200:203], v[112:115]
    ds_read_b128 v[160:163], v14 offset:4096
    v_mfma_f32_16x16x32_bf16 v[84:87], v[180:183], v[200:203], v[84:87]
    ds_read_b128 v[164:167], v14 offset:5120
    v_mfma_f32_16x16x32_bf16 v[56:59], v[176:179], v[200:203], v[56:59]
    ds_read_b128 v[168:171], v14 offset:6144
    v_mfma_f32_16x16x32_bf16 v[28:31], v[172:175], v[200:203], v[28:31]
    v_mfma_f32_16x16x32_bf16 v[32:35], v[172:175], v[204:207], v[32:35]
    v_mfma_f32_16x16x32_bf16 v[60:63], v[176:179], v[204:207], v[60:63]
    v_mfma_f32_16x16x32_bf16 v[88:91], v[180:183], v[204:207], v[88:91]
    v_mfma_f32_16x16x32_bf16 v[116:119], v[184:187], v[204:207], v[116:119]
    v_mfma_f32_16x16x32_bf16 v[120:123], v[184:187], v[208:211], v[120:123]
    v_mfma_f32_16x16x32_bf16 v[92:95], v[180:183], v[208:211], v[92:95]
    v_mfma_f32_16x16x32_bf16 v[64:67], v[176:179], v[208:211], v[64:67]
    v_mfma_f32_16x16x32_bf16 v[36:39], v[172:175], v[208:211], v[36:39]
    v_mfma_f32_16x16x32_bf16 v[40:43], v[172:175], v[212:215], v[40:43]
    v_mfma_f32_16x16x32_bf16 v[68:71], v[176:179], v[212:215], v[68:71]
    v_mfma_f32_16x16x32_bf16 v[96:99], v[180:183], v[212:215], v[96:99]
    v_mfma_f32_16x16x32_bf16 v[124:127], v[184:187], v[212:215], v[124:127]
    s_add_u32 s85, s85, 1
    s_cmp_lt_u32 s85, s101
    s_cbranch_scc1 L_o
L_o_out:
    s_setprio 0
    v_cvt_pk_bf16_f32 v44, v44, v45
    v_cvt_pk_bf16_f32 v45, v46, v47
    v_cvt_pk_bf16_f32 v46, v48, v49
    v_cvt_pk_bf16_f32 v47, v50, v51
    buffer_store_dwordx4 v[44:47], v14, s[60:63], s5 offen offset:0 sc1
    v_cvt_pk_bf16_f32 v52, v52, v53
    v_cvt_pk_bf16_f32 v53, v54, v55
    v_cvt_pk_bf16_f32 v54, v56, v57
    v_cvt_pk_bf16_f32 v55, v58, v59
    buffer_store_dwordx4 v[52:55], v14, s[60:63], s5 offen offset:1024 sc1
    v_cvt_pk_bf16_f32 v60, v60, v61
    v_cvt_pk_bf16_f32 v61, v62, v63
    v_cvt_pk_bf16_f32 v62, v64, v65
    v_cvt_pk_bf16_f32 v63, v66, v67
    buffer_store_dwordx4 v[60:63], v14, s[60:63], s5 offen offset:2048 sc1
    v_cvt_pk_bf16_f32 v68, v68, v69
    v_cvt_pk_bf16_f32 v69, v70, v71
    buffer_store_dwordx2 v[68:69], v15, s[60:63], s5 offen offset:3072 sc1
    v_cvt_pk_bf16_f32 v72, v72, v73
    v_cvt_pk_bf16_f32 v73, v74, v75
    v_cvt_pk_bf16_f32 v74, v76, v77
    v_cvt_pk_bf16_f32 v75, v78, v79
    buffer_store_dwordx4 v[72:75], v14, s[60:63], s6 offen offset:0 sc1
    v_cvt_pk_bf16_f32 v80, v80, v81
    v_cvt_pk_bf16_f32 v81, v82, v83
    v_cvt_pk_bf16_f32 v82, v84, v85
    v_cvt_pk_bf16_f32 v83, v86, v87
    buffer_store_dwordx4 v[80:83], v14, s[60:63], s6 offen offset:1024 sc1
    v_cvt_pk_bf16_f32 v88, v88, v89
    v_cvt_pk_bf16_f32 v89, v90, v91
    v_cvt_pk_bf16_f32 v90, v92, v93
    v_cvt_pk_bf16_f32 v91, v94, v95
    buffer_store_dwordx4 v[88:91], v14, s[60:63], s6 offen offset:2048 sc1
    v_cvt_pk_bf16_f32 v96, v96, v97
    v_cvt_pk_bf16_f32 v97, v98, v99
    buffer_store_dwordx2 v[96:97], v15, s[60:63], s6 offen offset:3072 sc1
    v_cvt_pk_bf16_f32 v100, v100, v101
    v_cvt_pk_bf16_f32 v101, v102, v103
    v_cvt_pk_bf16_f32 v102, v104, v105
    v_cvt_pk_bf16_f32 v103, v106, v107
    buffer_store_dwordx4 v[100:103], v14, s[60:63], s7 offen offset:0 sc1
    v_cvt_pk_bf16_f32 v108, v108, v109
    v_cvt_pk_bf16_f32 v109, v110, v111
    v_cvt_pk_bf16_f32 v110, v112, v113
    v_cvt_pk_bf16_f32 v111, v114, v115
    buffer_store_dwordx4 v[108:111], v14, s[60:63], s7 offen offset:1024 sc1
    v_cvt_pk_bf16_f32 v116, v116, v117
    v_cvt_pk_bf16_f32 v117, v118, v119
    v_cvt_pk_bf16_f32 v118, v120, v121
    v_cvt_pk_bf16_f32 v119, v122, v123
    buffer_store_dwordx4 v[116:119], v14, s[60:63], s7 offen offset:2048 sc1
    v_cvt_pk_bf16_f32 v124, v124, v125
    v_cvt_pk_bf16_f32 v125, v126, v127
    buffer_store_dwordx2 v[124:125], v15, s[60:63], s7 offen offset:3072 sc1
    v_cmp_eq_u32 vcc, 0, v236
    s_cbranch_vccz L_pt2_out
    s_mov_b32 s89, 0
L_pt2:
    buffer_load_dword v236, v4, s[40:43], 0 offen sc1
    s_add_u32 s89, s89, 1
    s_waitcnt vmcnt(0)
    v_cmp_eq_u32 vcc, 0, v236
    s_cmp_ge_u32 s89, 400000
    s_cbranch_scc1 L_pt2_out
    s_cbranch_vccnz L_pt2
L_pt2_out:
    s_waitcnt lgkmcnt(0) vmcnt(0)
    buffer_load_dword v9, v6, s[60:63], 0 offen sc1
    s_mov_b64 exec, 1
    buffer_store_dword v236, v5, s[60:63], 0 offen sc1
    s_mov_b64 exec, -1
    s_mov_b32 s30, 7
    s_mov_b32 s89, 0
    s_waitcnt vmcnt(1)
L_rx:
    v_cmp_eq_u32 vcc, v236, v9
    s_add_u32 s89, s89, 1
    s_nop 0
    s_cmp_ge_u32 s89, 400000
    s_cselect_b32 s31, 7, vcc_lo
    s_and_b32 s31, s31, s30
    s_andn2_b32 s30, s30, s31
    s_bitcmp1_b32 s31, 0
    s_cbranch_scc0 L_rx_l0
    buffer_load_dwordx4 v[128:131], v14, s[60:63], s8 offen offset:0 sc1
    buffer_load_dwordx4 v[132:135], v14, s[60:63], s8 offen offset:1024 sc1
    buffer_load_dwordx4 v[136:139], v14, s[60:63], s8 offen offset:2048 sc1
    buffer_load_dwordx2 v[140:141], v15, s[60:63], s8 offen offset:3072 sc1
L_rx_l0:
    s_bitcmp1_b32 s31, 1
    s_cbranch_scc0 L_rx_l1
    buffer_load_dwordx4 v[144:147], v14, s[60:63], s9 offen offset:0 sc1
    buffer_load_dwordx4 v[148:151], v14, s[60:63], s9 offen offset:1024 sc1
    buffer_load_dwordx4 v[152:155], v14, s[60:63], s9 offen offset:2048 sc1
    buffer_load_dwordx2 v[156:157], v15, s[60:63], s9 offen offset:3072 sc1
L_rx_l1:
    s_bitcmp1_b32 s31, 2
    s_cbranch_scc0 L_rx_l2
    buffer_load_dwordx4 v[160:163], v14, s[60:63], s10 offen offset:0 sc1
    buffer_load_dwordx4 v[164:167], v14, s[60:63], s10 offen offset:1024 sc1
    buffer_load_dwordx4 v[168:171], v14, s[60:63], s10 offen offset:2048 sc1
    buffer_load_dwordx2 v[172:173], v15, s[60:63], s10 offen offset:3072 sc1
L_rx_l2:
    s_cmp_eq_u32 s30, 0
    s_cbranch_scc1 L_rx_done
    buffer_load_dword v9, v6, s[60:63], 0 offen sc1
    s_waitcnt vmcnt(0)
    s_branch L_rx
L_rx_done:
    s_waitcnt vmcnt(0)
    v_dot2_f32_bf16 v16, v128, s12, v16
    v_dot2_f32_bf16 v17, v128, s13, v17
    v_dot2_f32_bf16 v18, v129, s12, v18
    v_dot2_f32_bf16 v19, v129, s13, v19
    v_dot2_f32_bf16 v20, v130, s12, v20
    v_dot2_f32_bf16 v21, v130, s13, v21
    v_dot2_f32_bf16 v22, v131, s12, v22
    v_dot2_f32_bf16 v23, v131, s13, v23
    v_dot2_f32_bf16 v16, v144, s12, v16
    v_dot2_f32_bf16 v17, v144, s13, v17
    v_dot2_f32_bf16 v18, v145, s12, v18
    v_dot2_f32_bf16 v19, v145, s13, v19
    v_dot2_f32_bf16 v20, v146, s12, v20
    v_dot2_f32_bf16 v21, v146, s13, v21
    v_dot2_f32_bf16 v22, v147, s12, v22
    v_dot2_f32_bf16 v23, v147, s13, v23
    v_dot2_f32_bf16 v16, v160, s12, v16
    v_dot2_f32_bf16 v17, v160, s13, v17
    v_dot2_f32_bf16 v18, v161, s12, v18
    v_dot2_f32_bf16 v19, v161, s13, v19
    v_dot2_f32_bf16 v20, v162, s12, v20
    v_dot2_f32_bf16 v21, v162, s13, v21
    v_dot2_f32_bf16 v22, v163, s12, v22
    v_dot2_f32_bf16 v23, v163, s13, v23
    s_mov_b32 s35, 0
    v_cvt_pk_bf16_f32 v16, v16, v17
    v_cvt_pk_bf16_f32 v17, v18, v19
    v_cvt_pk_bf16_f32 v18, v20, v21
    v_cvt_pk_bf16_f32 v19, v22, v23
    s_nop 1
    v_permlane16_swap_b32 v16, v18
    v_permlane16_swap_b32 v17, v19
    buffer_store_dwordx4 v[16:19], v8, s[36:39], s35 offen
    v_dot2_f32_bf16 v24, v132, s12, v24
    v_dot2_f32_bf16 v25, v132, s13, v25
    v_dot2_f32_bf16 v26, v133, s12, v26
    v_dot2_f32_bf16 v27, v133, s13, v27
    v_dot2_f32_bf16 v28, v134, s12, v28
    v_dot2_f32_bf16 v29, v134, s13, v29
    v_dot2_f32_bf16 v30, v135, s12, v30
    v_dot2_f32_bf16 v31, v135, s13, v31
    v_dot2_f32_bf16 v24, v148, s12, v24
    v_dot2_f32_bf16 v25, v148, s13, v25
    v_dot2_f32_bf16 v26, v149, s12, v26
    v_dot2_f32_bf16 v27, v149, s13, v27
    v_dot2_f32_bf16 v28, v150, s12, v28
    v_dot2_f32_bf16 v29, v150, s13, v29
    v_dot2_f32_bf16 v30, v151, s12, v30
    v_dot2_f32_bf16 v31, v151, s13, v31
    v_dot2_f32_bf16 v24, v164, s12, v24
    v_dot2_f32_bf16 v25, v164, s13, v25
    v_dot2_f32_bf16 v26, v165, s12, v26
    v_dot2_f32_bf16 v27, v165, s13, v27
    v_dot2_f32_bf16 v28, v166, s12, v28
    v_dot2_f32_bf16 v29, v166, s13, v29
    v_dot2_f32_bf16 v30, v167, s12, v30
    v_dot2_f32_bf16 v31, v167, s13, v31
    s_mov_b32 s35, 131072
    v_cvt_pk_bf16_f32 v24, v24, v25
    v_cvt_pk_bf16_f32 v25, v26, v27
    v_cvt_pk_bf16_f32 v26, v28, v29
    v_cvt_pk_bf16_f32 v27, v30, v31
    s_nop 1
    v_permlane16_swap_b32 v24, v26
    v_permlane16_swap_b32 v25, v27
    buffer_store_dwordx4 v[24:27], v8, s[36:39], s35 offen
    v_dot2_f32_bf16 v32, v136, s12, v32
    v_dot2_f32_bf16 v33, v136, s13, v33
    v_dot2_f32_bf16 v34, v137, s12, v34
    v_dot2_f32_bf16 v35, v137, s13, v35
    v_dot2_f32_bf16 v36, v138, s12, v36
    v_dot2_f32_bf16 v37, v138, s13, v37
    v_dot2_f32_bf16 v38, v139, s12, v38
    v_dot2_f32_bf16 v39, v139, s13, v39
    v_dot2_f32_bf16 v32, v152, s12, v32
    v_dot2_f32_bf16 v33, v152, s13, v33
    v_dot2_f32_bf16 v34, v153, s12, v34
    v_dot2_f32_bf16 v35, v153, s13, v35
    v_dot2_f32_bf16 v36, v154, s12, v36
    v_dot2_f32_bf16 v37, v154, s13, v37
    v_dot2_f32_bf16 v38, v155, s12, v38
    v_dot2_f32_bf16 v39, v155, s13, v39
    v_dot2_f32_bf16 v32, v168, s12, v32
    v_dot2_f32_bf16 v33, v168, s13, v33
    v_dot2_f32_bf16 v34, v169, s12, v34
    v_dot2_f32_bf16 v35, v169, s13, v35
    v_dot2_f32_bf16 v36, v170, s12, v36
    v_dot2_f32_bf16 v37, v170, s13, v37
    v_dot2_f32_bf16 v38, v171, s12, v38
    v_dot2_f32_bf16 v39, v171, s13, v39
    s_mov_b32 s35, 262144
    v_cvt_pk_bf16_f32 v32, v32, v33
    v_cvt_pk_bf16_f32 v33, v34, v35
    v_cvt_pk_bf16_f32 v34, v36, v37
    v_cvt_pk_bf16_f32 v35, v38, v39
    s_nop 1
    v_permlane16_swap_b32 v32, v34
    v_permlane16_swap_b32 v33, v35
    buffer_store_dwordx4 v[32:35], v8, s[36:39], s35 offen
    v_dot2_f32_bf16 v40, v140, s12, v40
    v_dot2_f32_bf16 v41, v140, s13, v41
    v_dot2_f32_bf16 v42, v141, s12, v42
    v_dot2_f32_bf16 v43, v141, s13, v43
    v_dot2_f32_bf16 v40, v156, s12, v40
    v_dot2_f32_bf16 v41, v156, s13, v41
    v_dot2_f32_bf16 v42, v157, s12, v42
    v_dot2_f32_bf16 v43, v157, s13, v43
    v_dot2_f32_bf16 v40, v172, s12, v40
    v_dot2_f32_bf16 v41, v172, s13, v41
    v_dot2_f32_bf16 v42, v173, s12, v42
    v_dot2_f32_bf16 v43, v173, s13, v43
    s_mov_b32 s35, 393216
    s_nop 1
    v_cvt_pk_bf16_f32 v40, v40, v41
    v_cvt_pk_bf16_f32 v41, v42, v43
    buffer_store_dwordx2 v[40:41], v7, s[36:39], s35 offen
L_end:
    s_endpgm
L_stub_11:
    s_call_b64 s[98:99], L_rare12
    s_branch L_back_12
L_stub_13:
    s_call_b64 s[98:99], L_rare02
    s_branch L_back_14
L_stub_16:
    s_call_b64 s[98:99], L_rare12
    s_branch L_back_17
L_stub_19:
    s_call_b64 s[98:99], L_rare02
    s_branch L_back_20
L_stub_22:
    s_call_b64 s[98:99], L_rare12
    s_branch L_back_23
L_stub_26:
    s_call_b64 s[98:99], L_rare02
    s_branch L_back_27
L_stub_30:
    s_call_b64 s[98:99], L_rare12
    s_branch L_back_31
L_stub_34:
    s_call_b64 s[98:99], L_rare11
    s_branch L_back_35
L_stub_36:
    s_call_b64 s[98:99], L_rare01
    s_branch L_back_37
L_stub_39:
    s_call_b64 s[98:99], L_rare11
    s_branch L_back_40
L_stub_42:
    s_call_b64 s[98:99], L_rare01
    s_branch L_back_43
L_stub_45:
    s_call_b64 s[98:99], L_rare11
    s_branch L_back_46
L_stub_49:
    s_call_b64 s[98:99], L_rare01
    s_branch L_back_50
L_stub_53:
    s_call_b64 s[98:99], L_rare11
    s_branch L_back_54
L_rare02:
    v_max3_f32 v234, v112, v113, v114
    v_max3_f32 v235, v115, v116, v117
    v_max3_f32 v234, v234, v118, v119
    v_max_f32 v234, v234, v235
    s_nop 0
    v_mov_b32 v235, v234
    s_nop 1
    v_permlane16_swap_b32 v235, v234
    s_nop 1
    v_max_f32 v234, v234, v235
    s_nop 0
    v_mov_b32 v235, v234
    s_nop 1
    v_permlane32_swap_b32 v235, v234
    s_nop 1
    v_max_f32 v234, v234, v235
    v_max_f32 v234, 0, v234
    v_exp_f32 v235, -v234
    v_sub_f32 v112, v112, v234
    v_sub_f32 v113, v113, v234
    v_sub_f32 v114, v114, v234
    v_sub_f32 v115, v115, v234
    v_sub_f32 v116, v116, v234
    v_sub_f32 v117, v117, v234
    v_sub_f32 v118, v118, v234
    v_sub_f32 v119, v119, v234
    v_sub_f32 v144, v144, v234
    v_sub_f32 v145, v145, v234
    v_sub_f32 v146, v146, v234
    v_sub_f32 v147, v147, v234
    v_mul_f32 v232, v232, v235
    v_mul_f32 v48, v48, v235
    v_mul_f32 v49, v49, v235
    v_mul_f32 v50, v50, v235
    v_mul_f32 v51, v51, v235
    v_mul_f32 v52, v52, v235
    v_mul_f32 v53, v53, v235
    v_mul_f32 v54, v54, v235
    v_mul_f32 v55, v55, v235
    v_mul_f32 v56, v56, v235
    v_mul_f32 v57, v57, v235
    v_mul_f32 v58, v58, v235
    v_mul_f32 v59, v59, v235
    v_mul_f32 v60, v60, v235
    v_mul_f32 v61, v61, v235
    v_mul_f32 v62, v62, v235
    v_mul_f32 v63, v63, v235
    v_mul_f32 v64, v64, v235
    v_mul_f32 v65, v65, v235
    v_mul_f32 v66, v66, v235
    v_mul_f32 v67, v67, v235
    v_mul_f32 v68, v68, v235
    v_mul_f32 v69, v69, v235
    v_mul_f32 v70, v70, v235
    v_mul_f32 v71, v71, v235
    v_mul_f32 v72, v72, v235
    v_mul_f32 v73, v73, v235
    v_mul_f32 v74, v74, v235
    v_mul_f32 v75, v75, v235
    v_mul_f32 v76, v76, v235
    v_mul_f32 v77, v77, v235
    v_mul_f32 v78, v78, v235
    v_mul_f32 v79, v79, v235
    v_max3_f32 v234, v120, v121, v122
    v_max3_f32 v235, v123, v124, v125
    v_max3_f32 v234, v234, v126, v127
    v_max_f32 v234, v234, v235
    s_nop 0
    v_mov_b32 v235, v234
    s_nop 1
    v_permlane16_swap_b32 v235, v234
    s_nop 1
    v_max_f32 v234, v234, v235
    s_nop 0
    v_mov_b32 v235, v234
    s_nop 1
    v_permlane32_swap_b32 v235, v234
    s_nop 1
    v_max_f32 v234, v234, v235
    v_max_f32 v234, 0, v234
    v_exp_f32 v235, -v234
    v_sub_f32 v120, v120, v234
    v_sub_f32 v121, v121, v234
    v_sub_f32 v122, v122, v234
    v_sub_f32 v123, v123, v234
    v_sub_f32 v124, v124, v234
    v_sub_f32 v125, v125, v234
    v_sub_f32 v126, v126, v234
    v_sub_f32 v127, v127, v234
    v_sub_f32 v148, v148, v234
    v_sub_f32 v149, v149, v234
    v_sub_f32 v150, v150, v234
    v_sub_f32 v151, v151, v234
    v_mul_f32 v233, v233, v235
    v_mul_f32 v80, v80, v235
    v_mul_f32 v81, v81, v235
    v_mul_f32 v82, v82, v235
    v_mul_f32 v83, v83, v235
    v_mul_f32 v84, v84, v235
    v_mul_f32 v85, v85, v235
    v_mul_f32 v86, v86, v235
    v_mul_f32 v87, v87, v235
    v_mul_f32 v88, v88, v235
    v_mul_f32 v89, v89, v235
    v_mul_f32 v90, v90, v235
    v_mul_f32 v91, v91, v235
    v_mul_f32 v92, v92, v235
    v_mul_f32 v93, v93, v235
    v_mul_f32 v94, v94, v235
    v_mul_f32 v95, v95, v235
    v_mul_f32 v96, v96, v235
    v_mul_f32 v97, v97, v235
    v_mul_f32 v98, v98, v235
    v_mul_f32 v99, v99, v235
    v_mul_f32 v100, v100, v235
    v_mul_f32 v101, v101, v235
    v_mul_f32 v102, v102, v235
    v_mul_f32 v103, v103, v235
    v_mul_f32 v104, v104, v235
    v_mul_f32 v105, v105, v235
    v_mul_f32 v106, v106, v235
    v_mul_f32 v107, v107, v235
    v_mul_f32 v108, v108, v235
    v_mul_f32 v109, v109, v235
    v_mul_f32 v110, v110, v235
    v_mul_f32 v111, v111, v235
    s_setpc_b64 s[98:99]
L_rare12:
    v_max3_f32 v234, v128, v129, v130
    v_max3_f32 v235, v131, v132, v133
    v_max3_f32 v234, v234, v134, v135
    v_max_f32 v234, v234, v235
    s_nop 0
    v_mov_b32 v235, v234
    s_nop 1
    v_permlane16_swap_b32 v235, v234
    s_nop 1
    v_max_f32 v234, v234, v235
    s_nop 0
    v_mov_b32 v235, v234
    s_nop 1
    v_permlane32_swap_b32 v235, v234
    s_nop 1
    v_max_f32 v234, v234, v235
    v_max_f32 v234, 0, v234
    v_exp_f32 v235, -v234
    v_sub_f32 v128, v128, v234
    v_sub_f32 v129, v129, v234
    v_sub_f32 v130, v130, v234
    v_sub_f32 v131, v131, v234
    v_sub_f32 v132, v132, v234
    v_sub_f32 v133, v133, v234
    v_sub_f32 v134, v134, v234
    v_sub_f32 v135, v135, v234
    v_sub_f32 v144, v144, v234
    v_sub_f32 v145, v145, v234
    v_sub_f32 v146, v146, v234
    v_sub_f32 v147, v147, v234
    v_mul_f32 v232, v232, v235
    v_mul_f32 v48, v48, v235
    v_mul_f32 v49, v49, v235
    v_mul_f32 v50, v50, v235
    v_mul_f32 v51, v51, v235
    v_mul_f32 v52, v52, v235
    v_mul_f32 v53, v53, v235
    v_mul_f32 v54, v54, v235
    v_mul_f32 v55, v55, v235
    v_mul_f32 v56, v56, v235
    v_mul_f32 v57, v57, v235
    v_mul_f32 v58, v58, v235
    v_mul_f32 v59, v59, v235
    v_mul_f32 v60, v60, v235
    v_mul_f32 v61, v61, v235
    v_mul_f32 v62, v62, v235
    v_mul_f32 v63, v63, v235
    v_mul_f32 v64, v64, v235
    v_mul_f32 v65, v65, v235
    v_mul_f32 v66, v66, v235
    v_mul_f32 v67, v67, v235
    v_mul_f32 v68, v68, v235
    v_mul_f32 v69, v69, v235
    v_mul_f32 v70, v70, v235
    v_mul_f32 v71, v71, v235
    v_mul_f32 v72, v72, v235
    v_mul_f32 v73, v73, v235
    v_mul_f32 v74, v74, v235
    v_mul_f32 v75, v75, v235
    v_mul_f32 v76, v76, v235
    v_mul_f32 v77, v77, v235
    v_mul_f32 v78, v78, v235
    v_mul_f32 v79, v79, v235
    v_max3_f32 v234, v136, v137, v138
    v_max3_f32 v235, v139, v140, v141
    v_max3_f32 v234, v234, v142, v143
    v_max_f32 v234, v234, v235
    s_nop 0
    v_mov_b32 v235, v234
    s_nop 1
    v_permlane16_swap_b32 v235, v234
    s_nop 1
    v_max_f32 v234, v234, v235
    s_nop 0
    v_mov_b32 v235, v234
    s_nop 1
    v_permlane32_swap_b32 v235, v234
    s_nop 1
    v_max_f32 v234, v234, v235
    v_max_f32 v234, 0, v234
    v_exp_f32 v235, -v234
    v_sub_f32 v136, v136, v234
    v_sub_f32 v137, v137, v234
    v_sub_f32 v138, v138, v234
    v_sub_f32 v139, v139, v234
    v_sub_f32 v140, v140, v234
    v_sub_f32 v141, v141, v234
    v_sub_f32 v142, v142, v234
    v_sub_f32 v143, v143, v234
    v_sub_f32 v148, v148, v234
    v_sub_f32 v149, v149, v234
    v_sub_f32 v150, v150, v234
    v_sub_f32 v151, v151, v234
    v_mul_f32 v233, v233, v235
    v_mul_f32 v80, v80, v235
    v_mul_f32 v81, v81, v235
    v_mul_f32 v82, v82, v235
    v_mul_f32 v83, v83, v235
    v_mul_f32 v84, v84, v235
    v_mul_f32 v85, v85, v235
    v_mul_f32 v86, v86, v235
    v_mul_f32 v87, v87, v235
    v_mul_f32 v88, v88, v235
    v_mul_f32 v89, v89, v235
    v_mul_f32 v90, v90, v235
    v_mul_f32 v91, v91, v235
    v_mul_f32 v92, v92, v235
    v_mul_f32 v93, v93, v235
    v_mul_f32 v94, v94, v235
    v_mul_f32 v95, v95, v235
    v_mul_f32 v96, v96, v235
    v_mul_f32 v97, v97, v235
    v_mul_f32 v98, v98, v235
    v_mul_f32 v99, v99, v235
    v_mul_f32 v100, v100, v235
    v_mul_f32 v101, v101, v235
    v_mul_f32 v102, v102, v235
    v_mul_f32 v103, v103, v235
    v_mul_f32 v104, v104, v235
    v_mul_f32 v105, v105, v235
    v_mul_f32 v106, v106, v235
    v_mul_f32 v107, v107, v235
    v_mul_f32 v108, v108, v235
    v_mul_f32 v109, v109, v235
    v_mul_f32 v110, v110, v235
    v_mul_f32 v111, v111, v235
    s_setpc_b64 s[98:99]
L_rare01:
    v_max3_f32 v234, v112, v113, v114
    v_max3_f32 v235, v115, v116, v117
    v_max3_f32 v234, v234, v118, v119
    v_max_f32 v234, v234, v235
    s_nop 0
    v_mov_b32 v235, v234
    s_nop 1
    v_permlane16_swap_b32 v235, v234
    s_nop 1
    v_max_f32 v234, v234, v235
    s_nop 0
    v_mov_b32 v235, v234
    s_nop 1
    v_permlane32_swap_b32 v235, v234
    s_nop 1
    v_max_f32 v234, v234, v235
    v_max_f32 v234, 0, v234
    v_exp_f32 v235, -v234
    v_sub_f32 v112, v112, v234
    v_sub_f32 v113, v113, v234
    v_sub_f32 v114, v114, v234
    v_sub_f32 v115, v115, v234
    v_sub_f32 v116, v116, v234
    v_sub_f32 v117, v117, v234
    v_sub_f32 v118, v118, v234
    v_sub_f32 v119, v119, v234
    v_sub_f32 v144, v144, v234
    v_sub_f32 v145, v145, v234
    v_sub_f32 v146, v146, v234
    v_sub_f32 v147, v147, v234
    v_mul_f32 v232, v232, v235
    v_mul_f32 v48, v48, v235
    v_mul_f32 v49, v49, v235
    v_mul_f32 v50, v50, v235
    v_mul_f32 v51, v51, v235
    v_mul_f32 v52, v52, v235
    v_mul_f32 v53, v53, v235
    v_mul_f32 v54, v54, v235
    v_mul_f32 v55, v55, v235
    v_mul_f32 v56, v56, v235
    v_mul_f32 v57, v57, v235
    v_mul_f32 v58, v58, v235
    v_mul_f32 v59, v59, v235
    v_mul_f32 v60, v60, v235
    v_mul_f32 v61, v61, v235
    v_mul_f32 v62, v62, v235
    v_mul_f32 v63, v63, v235
    v_mul_f32 v64, v64, v235
    v_mul_f32 v65, v65, v235
    v_mul_f32 v66, v66, v235
    v_mul_f32 v67, v67, v235
    v_mul_f32 v68, v68, v235
    v_mul_f32 v69, v69, v235
    v_mul_f32 v70, v70, v235
    v_mul_f32 v71, v71, v235
    v_mul_f32 v72, v72, v235
    v_mul_f32 v73, v73, v235
    v_mul_f32 v74, v74, v235
    v_mul_f32 v75, v75, v235
    v_mul_f32 v76, v76, v235
    v_mul_f32 v77, v77, v235
    v_mul_f32 v78, v78, v235
    v_mul_f32 v79, v79, v235
    s_setpc_b64 s[98:99]
L_rare11:
    v_max3_f32 v234, v128, v129, v130
    v_max3_f32 v235, v131, v132, v133
    v_max3_f32 v234, v234, v134, v135
    v_max_f32 v234, v234, v235
    s_nop 0
    v_mov_b32 v235, v234
    s_nop 1
    v_permlane16_swap_b32 v235, v234
    s_nop 1
    v_max_f32 v234, v234, v235
    s_nop 0
    v_mov_b32 v235, v234
    s_nop 1
    v_permlane32_swap_b32 v235, v234
    s_nop 1
    v_max_f32 v234, v234, v235
    v_max_f32 v234, 0, v234
    v_exp_f32 v235, -v234
    v_sub_f32 v128, v128, v234
    v_sub_f32 v129, v129, v234
    v_sub_f32 v130, v130, v234
    v_sub_f32 v131, v131, v234
    v_sub_f32 v132, v132, v234
    v_sub_f32 v133, v133, v234
    v_sub_f32 v134, v134, v234
    v_sub_f32 v135, v135, v234
    v_sub_f32 v144, v144, v234
    v_sub_f32 v145, v145, v234
    v_sub_f32 v146, v146, v234
    v_sub_f32 v147, v147, v234
    v_mul_f32 v232, v232, v235
    v_mul_f32 v48, v48, v235
    v_mul_f32 v49, v49, v235
    v_mul_f32 v50, v50, v235
    v_mul_f32 v51, v51, v235
    v_mul_f32 v52, v52, v235
    v_mul_f32 v53, v53, v235
    v_mul_f32 v54, v54, v235
    v_mul_f32 v55, v55, v235
    v_mul_f32 v56, v56, v235
    v_mul_f32 v57, v57, v235
    v_mul_f32 v58, v58, v235
    v_mul_f32 v59, v59, v235
    v_mul_f32 v60, v60, v235
    v_mul_f32 v61, v61, v235
    v_mul_f32 v62, v62, v235
    v_mul_f32 v63, v63, v235
    v_mul_f32 v64, v64, v235
    v_mul_f32 v65, v65, v235
    v_mul_f32 v66, v66, v235
    v_mul_f32 v67, v67, v235
    v_mul_f32 v68, v68, v235
    v_mul_f32 v69, v69, v235
    v_mul_f32 v70, v70, v235
    v_mul_f32 v71, v71, v235
    v_mul_f32 v72, v72, v235
    v_mul_f32 v73, v73, v235
    v_mul_f32 v74, v74, v235
    v_mul_f32 v75, v75, v235
    v_mul_f32 v76, v76, v235
    v_mul_f32 v77, v77, v235
    v_mul_f32 v78, v78, v235
    v_mul_f32 v79, v79, v235
    s_setpc_b64 s[98:99]
.section .rodata,"a"
.p2align 6
.amdhsa_kernel concat_heads__mha_block_cached__gqa_block_cached__near_ridge_kernel
  .amdhsa_next_free_vgpr 248
  .amdhsa_next_free_sgpr 102
  .amdhsa_accum_offset 248
  .amdhsa_group_segment_fixed_size 0
  .amdhsa_kernarg_size 104
  .amdhsa_user_sgpr_count 2
  .amdhsa_user_sgpr_kernarg_segment_ptr 1
  .amdhsa_system_sgpr_workgroup_id_x 1
  .amdhsa_float_denorm_mode_32 3
.end_amdhsa_kernel
```
